```python
import torch

def _softmax(x, axis=-1):
    return torch.softmax(x, dim=axis)
def _gelu(x):
    return torch.nn.functional.gelu(x, approximate="tanh")
def _silu(x):
    return torch.nn.functional.silu(x)
def _sigmoid(x):
    return torch.sigmoid(x)
def _layernorm(x, axis=-1, eps=1e-5):
    m = x.mean(dim=axis, keepdim=True)
    v = x.var(dim=axis, keepdim=True, unbiased=False)
    return (x - m) / torch.sqrt(v + eps)
def _scatter_add(tgt, idx, src, axis=0):
    return tgt.clone().index_add_(axis, idx, src)
def _segment_sum(src, seg, n):
    out = torch.zeros((n,) + src.shape[1:], dtype=src.dtype)
    return out.index_add_(0, seg, src)
def _pad(x, pw):
    flat = tuple(v for pair in reversed(pw) for v in pair)
    return torch.nn.functional.pad(x, flat)

kernel_name = 'standalone__sliding_block_cached__decode'

def setup_inputs():

    _w = (lambda a: (lambda t: t.to(torch.bfloat16) if t.is_floating_point() else t)(torch.as_tensor(a)))
    B, Sq, D = 2, 1, 640
    Hq, Hkv, Sk, Dh = 32, 32, 16384, 128
    assert Hq % Hkv == 0, (Hq, Hkv)
    return {
        "x": _w((lambda *s: torch.randn(*s, dtype=torch.bfloat16) * 0.8)(B, Sq, D)),
        "k_cache": _w((lambda *s: torch.randn(*s, dtype=torch.bfloat16) * 0.8)(B, Hkv, Sk, Dh)),
        "v_cache": _w((lambda *s: torch.randn(*s, dtype=torch.bfloat16) * 0.05)(B, Hkv, Sk, Dh)),
        "wq": _w((lambda *s: torch.randn(*s, dtype=torch.bfloat16) * 0.8)(D, Hq * Dh) * (D ** -0.5)),
        "wo": _w((lambda *s: torch.randn(*s, dtype=torch.bfloat16) * 0.05)(Hq * Dh, D) * ((Hq * Dh) ** -0.5)),
    }

def reference(x, k_cache, v_cache, wq, wo):
    B, Sq, D = x.shape
    Hq, Dh = 32, 128
    Hkv, Sk = k_cache.shape[1], k_cache.shape[2]
    W = min(4096, max(256, Sk // 4))
    rep = Hq // Hkv
    q = (lambda x, *d: x.permute(*d))((x @ wq).reshape(B, Sq, Hq, Dh), 0, 2, 1, 3)
    k = (lambda x, n, axis: torch.repeat_interleave(x, n, dim=axis))(k_cache[:, :, Sk - W:, :], rep, axis=1)
    v = (lambda x, n, axis: torch.repeat_interleave(x, n, dim=axis))(v_cache[:, :, Sk - W:, :], rep, axis=1)
    scores = torch.einsum("bhqd,bhkd->bhqk", q, k) * (Dh ** -0.5)
    p = _softmax(scores, axis=-1)
    o = torch.einsum("bhqk,bhkd->bhqd", p, v)
    return (lambda x, *d: x.permute(*d))(o, 0, 2, 1, 3).reshape(B, Sq, Hq * Dh) @ wo
```

```asm
; @launch grid=(256,1,1) block=(512,1,1) lds=24576
.amdgcn_target "amdgcn-amd-amdhsa--gfx950"
.text
.globl standalone__sliding_block_cached__decode_kernel
.p2align 12
.fill 832, 4, 0xbf810000
.p2align 8
.type standalone__sliding_block_cached__decode_kernel,@function
standalone__sliding_block_cached__decode_kernel:
    s_load_dwordx2 s[8:9], s[0:1], 8
    s_load_dwordx2 s[16:17], s[0:1], 24
    s_load_dwordx2 s[4:5], s[0:1], 0
    s_load_dwordx2 s[12:13], s[0:1], 16
    s_load_dwordx2 s[28:29], s[0:1], 56
    s_load_dwordx2 s[20:21], s[0:1], 32
    s_load_dwordx2 s[24:25], s[0:1], 40
    v_lshrrev_b32 v12, 6, v0
    s_cmp_ge_u32 s2, 0x100
    s_cbranch_scc1 L_exit
    v_readfirstlane_b32 s32, v12
    s_and_b32 s33, s2, 31
    s_lshr_b32 s34, s2, 5
    s_cmp_lt_u32 s32, 4
    s_cbranch_scc1 L_stream
    v_and_b32 v1, 63, v0
    v_bfe_u32 v12, v0, 4, 2
    v_and_b32 v13, 15, v0
    s_cmp_eq_u32 s32, 6
    s_cbranch_scc1 L_pg0
    s_cmp_lg_u32 s32, 4
    s_cbranch_scc1 L_service
    s_mov_b32 s18, 0x500000
    s_mov_b32 s19, 0x20000
    s_mov_b32 s6, 0xa00
    s_mov_b32 s7, 0x20000
    s_mul_i32 s43, s34, 655360
    s_lshl_b32 s37, s33, 8
    s_add_u32 s43, s43, s37
    s_mul_i32 s44, s34, 160
    v_mul_u32_u24 v2, 163840, v12
    v_lshl_add_u32 v2, v13, 4, v2
    v_lshrrev_b32 v14, 3, v13
    v_mul_u32_u24 v14, 1280, v14
    v_mad_u32_u24 v3, v12, 40, v14
    s_waitcnt lgkmcnt(0)
    buffer_load_dwordx4 v[20:23], v3, s[4:7], s44 offen
    buffer_load_dwordx4 v[24:27], v3, s[4:7], s44 offen offset:16
    buffer_load_dwordx2 v[28:29], v3, s[4:7], s44 offen offset:32
    buffer_load_dwordx4 v[48:51], v2, s[16:19], s43 offen nt
    s_addk_i32 s43, 0x2000
    buffer_load_dwordx4 v[52:55], v2, s[16:19], s43 offen nt
    s_addk_i32 s43, 0x2000
    buffer_load_dwordx4 v[56:59], v2, s[16:19], s43 offen nt
    s_addk_i32 s43, 0x2000
    buffer_load_dwordx4 v[60:63], v2, s[16:19], s43 offen nt
    s_addk_i32 s43, 0x2000
    buffer_load_dwordx4 v[64:67], v2, s[16:19], s43 offen nt
    s_addk_i32 s43, 0x2000
    buffer_load_dwordx4 v[68:71], v2, s[16:19], s43 offen nt
    s_addk_i32 s43, 0x2000
    buffer_load_dwordx4 v[72:75], v2, s[16:19], s43 offen nt
    s_addk_i32 s43, 0x2000
    buffer_load_dwordx4 v[76:79], v2, s[16:19], s43 offen nt
    s_addk_i32 s43, 0x2000
    buffer_load_dwordx4 v[80:83], v2, s[16:19], s43 offen nt
    s_addk_i32 s43, 0x2000
    buffer_load_dwordx4 v[84:87], v2, s[16:19], s43 offen nt
    s_addk_i32 s43, 0x2000
    buffer_load_dwordx4 v[88:91], v2, s[16:19], s43 offen nt
    s_addk_i32 s43, 0x2000
    buffer_load_dwordx4 v[92:95], v2, s[16:19], s43 offen nt
    s_addk_i32 s43, 0x2000
    buffer_load_dwordx4 v[96:99], v2, s[16:19], s43 offen nt
    s_addk_i32 s43, 0x2000
    buffer_load_dwordx4 v[100:103], v2, s[16:19], s43 offen nt
    s_addk_i32 s43, 0x2000
    buffer_load_dwordx4 v[104:107], v2, s[16:19], s43 offen nt
    s_addk_i32 s43, 0x2000
    buffer_load_dwordx4 v[108:111], v2, s[16:19], s43 offen nt
    s_addk_i32 s43, 0x2000
    buffer_load_dwordx4 v[112:115], v2, s[16:19], s43 offen nt
    s_addk_i32 s43, 0x2000
    buffer_load_dwordx4 v[116:119], v2, s[16:19], s43 offen nt
    s_addk_i32 s43, 0x2000
    buffer_load_dwordx4 v[120:123], v2, s[16:19], s43 offen nt
    s_addk_i32 s43, 0x2000
    buffer_load_dwordx4 v[124:127], v2, s[16:19], s43 offen nt
    s_branch L_lead
L_stream:
    s_lshl_b32 s35, s33, 22
    s_add_u32 s35, s35, 0x300000
    s_and_b32 s37, s2, 0xe0
    s_mul_i32 s37, s37, 0x100490
    s_and_b32 s37, s37, 0x8014200
    s_xor_b32 s35, s35, s37
    s_and_b32 s37, s2, 0x8
    s_mul_i32 s37, s37, 0x4000
    s_and_b32 s37, s37, 0x20000
    s_xor_b32 s35, s35, s37
    s_mul_i32 s37, s32, 0x5000
    s_and_b32 s37, s37, 0xb000
    s_xor_b32 s35, s35, s37
    s_mov_b32 s10, 0x10000000
    s_mov_b32 s11, 0x20000
    v_and_b32 v14, 3, v0
    v_and_b32 v15, 48, v0
    v_and_b32 v16, 12, v0
    v_lshlrev_b32 v14, 4, v14
    v_lshl_or_b32 v10, v15, 2, v14
    v_lshl_or_b32 v2, v16, 8, v10
    s_waitcnt lgkmcnt(0)
    buffer_load_dwordx4 v[56:59], v2, s[8:11], s35 offen offset:0 nt
    s_xor_b32 s36, s35, 0x12000
    buffer_load_dwordx4 v[60:63], v2, s[8:11], s36 offen offset:256 nt
    s_xor_b32 s36, s35, 0x9000
    buffer_load_dwordx4 v[64:67], v2, s[8:11], s36 offen offset:0 nt
    s_xor_b32 s36, s35, 0x1b000
    buffer_load_dwordx4 v[68:71], v2, s[8:11], s36 offen offset:256 nt
    s_xor_b32 s36, s35, 0x24000
    buffer_load_dwordx4 v[72:75], v2, s[8:11], s36 offen offset:0 nt
    s_mov_b32 s14, 0x10000000
    s_mov_b32 s15, 0x20000
    s_mov_b32 s22, 0x500000
    s_mov_b32 s23, 0x20000
    s_mov_b32 s30, 0x40000000
    s_mov_b32 s31, 0x20000
    s_mov_b32 s26, 0xa00
    s_mov_b32 s27, 0x20000
    s_load_dword s42, s[28:29], 0xd0000
    s_mov_b32 s41, 0
    v_and_b32 v1, 63, v0
    v_and_b32 v13, 15, v0
    v_lshlrev_b32 v3, 6, v15
    v_lshl_add_u32 v3, v13, 4, v3
    v_and_b32 v14, 1, v1
    v_lshlrev_b32 v14, 4, v14
    v_mov_b32 v15, 0xffff
    v_lshlrev_b32 v14, v14, v15
    v_bfe_u32 v15, v1, 1, 2
    v_cmp_eq_u32 vcc, 0, v15
    v_mov_b32 v24, 0
    v_mov_b32 v25, 0
    v_cndmask_b32 v4, 0, v14, vcc
    v_mov_b32 v26, 0
    v_mov_b32 v27, 0
    v_cmp_eq_u32 vcc, 1, v15
    v_mov_b32 v28, 0
    v_mov_b32 v29, 0
    v_cndmask_b32 v5, 0, v14, vcc
    v_mov_b32 v30, 0
    v_mov_b32 v31, 0
    v_cmp_eq_u32 vcc, 2, v15
    v_mov_b32 v32, 0
    v_mov_b32 v33, 0
    v_cndmask_b32 v6, 0, v14, vcc
    v_mov_b32 v34, 0
    v_mov_b32 v35, 0
    v_cmp_eq_u32 vcc, 3, v15
    v_mov_b32 v36, 0
    v_mov_b32 v37, 0
    v_cndmask_b32 v7, 0, v14, vcc
    v_mov_b32 v38, 0
    v_mov_b32 v39, 0
    s_mov_b32 s40, 0x3e0293ee
    v_lshlrev_b32 v13, 5, v13
    v_and_b32 v14, 16, v1
    s_lshl_b32 s37, s32, 9
    v_add3_u32 v9, v13, v14, s37
    s_lshl_b32 s37, s32, 2
    v_mov_b32 v252, s37
    ds_write_b32 v252, v24 offset:320
    s_mov_b64 vcc, 0
    s_xor_b32 s36, s35, 0x36000
    s_waitcnt vmcnt(4)
    buffer_load_dwordx4 v[76:79], v2, s[8:11], s36 offen offset:256 nt
    v_mov_b32 v254, 5
    ds_write_b32 v252, v254 offset:352
    s_xor_b32 s36, s35, 0x2d000
    s_waitcnt vmcnt(4)
    buffer_load_dwordx4 v[80:83], v2, s[8:11], s36 offen offset:0 nt
    v_mov_b32 v254, 6
    ds_write_b32 v252, v254 offset:352
    s_xor_b32 s36, s35, 0x3f000
    s_waitcnt vmcnt(4)
    buffer_load_dwordx4 v[84:87], v2, s[8:11], s36 offen offset:256 nt
    v_mov_b32 v254, 7
    ds_write_b32 v252, v254 offset:352
    s_xor_b32 s36, s35, 0x40000
    s_waitcnt vmcnt(4)
    buffer_load_dwordx4 v[88:91], v2, s[8:11], s36 offen offset:0 nt
    v_mov_b32 v254, 8
    ds_write_b32 v252, v254 offset:352
    s_xor_b32 s36, s35, 0x52000
    s_waitcnt vmcnt(4)
    buffer_load_dwordx4 v[92:95], v2, s[8:11], s36 offen offset:256 nt
    v_mov_b32 v254, 9
    ds_write_b32 v252, v254 offset:352
    s_xor_b32 s36, s35, 0x49000
    s_waitcnt vmcnt(4)
    buffer_load_dwordx4 v[96:99], v2, s[8:11], s36 offen offset:0 nt
    v_mov_b32 v254, 10
    ds_write_b32 v252, v254 offset:352
    s_xor_b32 s36, s35, 0x5b000
    s_waitcnt vmcnt(4)
    buffer_load_dwordx4 v[100:103], v2, s[8:11], s36 offen offset:256 nt
    v_mov_b32 v254, 11
    ds_write_b32 v252, v254 offset:352
    s_xor_b32 s36, s35, 0x64000
    s_waitcnt vmcnt(4)
    buffer_load_dwordx4 v[104:107], v2, s[8:11], s36 offen offset:0 nt
    ds_read_b32 v253, v252 offset:320
    v_mov_b32 v254, 12
    ds_write_b32 v252, v254 offset:352
    s_xor_b32 s36, s35, 0x76000
    s_cbranch_vccnz L_b13
    s_waitcnt vmcnt(4)
L_b13:
    buffer_load_dwordx4 v[108:111], v2, s[8:11], s36 offen offset:256 nt
    s_waitcnt lgkmcnt(0)
    v_cmp_eq_u32 vcc, 1, v253
    v_mov_b32 v254, 13
    ds_write_b32 v252, v254 offset:352
    s_xor_b32 s36, s35, 0x6d000
    s_cbranch_vccnz L_b14
    s_waitcnt vmcnt(4)
L_b14:
    buffer_load_dwordx4 v[112:115], v2, s[8:11], s36 offen offset:0 nt
    ds_read_b32 v253, v252 offset:320
    v_mov_b32 v254, 14
    ds_write_b32 v252, v254 offset:352
    s_xor_b32 s36, s35, 0x7f000
    s_cbranch_vccnz L_b15
    s_waitcnt vmcnt(4)
L_b15:
    s_waitcnt vmcnt(6)
    buffer_load_dwordx4 v[116:119], v2, s[8:11], s36 offen offset:256 nt
    s_waitcnt lgkmcnt(0)
    v_cmp_eq_u32 vcc, 1, v253
    v_mov_b32 v254, 15
    ds_write_b32 v252, v254 offset:352
    s_xor_b32 s36, s35, 0xa0000
    s_cbranch_vccnz L_b16
    s_waitcnt vmcnt(4)
L_b16:
    s_waitcnt vmcnt(6)
    buffer_load_dwordx4 v[120:123], v2, s[8:11], s36 offen offset:0 nt
    ds_read_b32 v253, v252 offset:320
    v_mov_b32 v254, 16
    ds_write_b32 v252, v254 offset:352
    s_xor_b32 s36, s35, 0xb2000
    s_cbranch_vccnz L_b17
    s_waitcnt vmcnt(4)
L_b17:
    s_waitcnt vmcnt(6)
    buffer_load_dwordx4 v[124:127], v2, s[8:11], s36 offen offset:256 nt
    s_waitcnt lgkmcnt(0)
    v_cmp_eq_u32 vcc, 1, v253
    v_mov_b32 v254, 17
    ds_write_b32 v252, v254 offset:352
    s_xor_b32 s36, s35, 0xa9000
    s_cbranch_vccnz L_b18
    s_waitcnt vmcnt(4)
L_b18:
    s_waitcnt vmcnt(6)
    buffer_load_dwordx4 v[128:131], v2, s[8:11], s36 offen offset:0 nt
    ds_read_b32 v253, v252 offset:320
    v_mov_b32 v254, 18
    ds_write_b32 v252, v254 offset:352
    s_xor_b32 s36, s35, 0xbb000
    s_cbranch_vccnz L_b19
    s_waitcnt vmcnt(4)
L_b19:
    s_waitcnt vmcnt(6)
    buffer_load_dwordx4 v[132:135], v2, s[8:11], s36 offen offset:256 nt
    s_waitcnt lgkmcnt(0)
    v_cmp_eq_u32 vcc, 1, v253
    v_mov_b32 v254, 19
    ds_write_b32 v252, v254 offset:352
    s_xor_b32 s36, s35, 0x84000
    s_cbranch_vccnz L_b20
    s_waitcnt vmcnt(4)
L_b20:
    s_waitcnt vmcnt(6)
    buffer_load_dwordx4 v[136:139], v2, s[8:11], s36 offen offset:0 nt
    ds_read_b32 v253, v252 offset:320
    v_mov_b32 v254, 20
    ds_write_b32 v252, v254 offset:352
    s_xor_b32 s36, s35, 0x96000
    s_cbranch_vccnz L_b21
    s_waitcnt vmcnt(4)
L_b21:
    s_waitcnt vmcnt(6)
    buffer_load_dwordx4 v[140:143], v2, s[8:11], s36 offen offset:256 nt
    s_waitcnt lgkmcnt(0)
    v_cmp_eq_u32 vcc, 1, v253
    v_mov_b32 v254, 21
    ds_write_b32 v252, v254 offset:352
    s_xor_b32 s36, s35, 0x8d000
    s_cbranch_vccnz L_b22
    s_waitcnt vmcnt(4)
L_b22:
    s_waitcnt vmcnt(6)
    buffer_load_dwordx4 v[144:147], v2, s[8:11], s36 offen offset:0 nt
    ds_read_b32 v253, v252 offset:320
    v_mov_b32 v254, 22
    ds_write_b32 v252, v254 offset:352
    s_xor_b32 s36, s35, 0x9f000
    s_cbranch_vccnz L_b23
    s_waitcnt vmcnt(4)
L_b23:
    s_waitcnt vmcnt(6)
    buffer_load_dwordx4 v[148:151], v2, s[8:11], s36 offen offset:256 nt
    s_waitcnt lgkmcnt(0)
    v_cmp_eq_u32 vcc, 1, v253
    v_mov_b32 v254, 23
    ds_write_b32 v252, v254 offset:352
    s_xor_b32 s36, s35, 0xe0000
    s_cbranch_vccnz L_b24
    s_waitcnt vmcnt(4)
L_b24:
    s_waitcnt vmcnt(6)
    buffer_load_dwordx4 v[152:155], v2, s[8:11], s36 offen offset:0 nt
    ds_read_b32 v253, v252 offset:320
    v_mov_b32 v254, 24
    ds_write_b32 v252, v254 offset:352
    s_xor_b32 s36, s35, 0xf2000
    s_cbranch_vccnz L_b25
    s_waitcnt vmcnt(4)
L_b25:
    s_waitcnt vmcnt(6)
    buffer_load_dwordx4 v[156:159], v2, s[8:11], s36 offen offset:256 nt
    s_waitcnt lgkmcnt(0)
    v_cmp_eq_u32 vcc, 1, v253
    v_mov_b32 v254, 25
    ds_write_b32 v252, v254 offset:352
    s_xor_b32 s36, s35, 0xe9000
    s_cbranch_vccnz L_b26
    s_waitcnt vmcnt(4)
L_b26:
    s_waitcnt vmcnt(6)
    buffer_load_dwordx4 v[160:163], v2, s[8:11], s36 offen offset:0 nt
    ds_read_b32 v253, v252 offset:320
    v_mov_b32 v254, 26
    ds_write_b32 v252, v254 offset:352
    s_xor_b32 s36, s35, 0xfb000
    s_cbranch_vccnz L_b27
    s_waitcnt vmcnt(4)
L_b27:
    s_waitcnt vmcnt(6)
    buffer_load_dwordx4 v[164:167], v2, s[8:11], s36 offen offset:256 nt
    s_waitcnt lgkmcnt(0)
    v_cmp_eq_u32 vcc, 1, v253
    v_mov_b32 v254, 27
    ds_write_b32 v252, v254 offset:352
    s_xor_b32 s36, s35, 0xc4000
    s_cbranch_vccnz L_b28
    s_waitcnt vmcnt(4)
L_b28:
    s_waitcnt vmcnt(6)
    buffer_load_dwordx4 v[168:171], v2, s[8:11], s36 offen offset:0 nt
    ds_read_b32 v253, v252 offset:320
    v_mov_b32 v254, 28
    ds_write_b32 v252, v254 offset:352
    s_xor_b32 s36, s35, 0xd6000
    s_cbranch_vccnz L_b29
    s_waitcnt vmcnt(4)
L_b29:
    s_waitcnt vmcnt(6)
    buffer_load_dwordx4 v[172:175], v2, s[8:11], s36 offen offset:256 nt
    s_waitcnt lgkmcnt(0)
    v_cmp_eq_u32 vcc, 1, v253
    v_mov_b32 v254, 29
    ds_write_b32 v252, v254 offset:352
    s_xor_b32 s36, s35, 0xcd000
    s_cbranch_vccnz L_b30
    s_waitcnt vmcnt(4)
L_b30:
    s_waitcnt vmcnt(6)
    s_branch L_pg0_skip
L_pg0:
    s_branch L_pg1
L_pg0_skip:
    buffer_load_dwordx4 v[176:179], v2, s[8:11], s36 offen offset:0 nt
    ds_read_b32 v253, v252 offset:320
    v_mov_b32 v254, 30
    ds_write_b32 v252, v254 offset:352
    s_xor_b32 s36, s35, 0xdf000
    s_cbranch_vccnz L_b31
    s_waitcnt vmcnt(4)
L_b31:
    s_waitcnt vmcnt(6)
    buffer_load_dwordx4 v[180:183], v2, s[8:11], s36 offen offset:256 nt
    s_waitcnt lgkmcnt(0)
    v_cmp_eq_u32 vcc, 1, v253
    v_mov_b32 v254, 31
    ds_write_b32 v252, v254 offset:352
    s_xor_b32 s36, s35, 0x4000
    s_cbranch_vccnz L_b32
    s_waitcnt vmcnt(4)
L_b32:
    s_waitcnt vmcnt(6)
    buffer_load_dwordx4 v[184:187], v2, s[8:11], s36 offen offset:0 nt
    ds_read_b32 v253, v252 offset:320
    v_mov_b32 v254, 32
    ds_write_b32 v252, v254 offset:352
    s_xor_b32 s36, s35, 0x16000
    s_cbranch_vccnz L_b33
    s_waitcnt vmcnt(4)
L_b33:
    s_waitcnt vmcnt(6)
    buffer_load_dwordx4 v[188:191], v2, s[8:11], s36 offen offset:256 nt
    s_waitcnt lgkmcnt(0)
    v_cmp_eq_u32 vcc, 1, v253
    v_mov_b32 v254, 33
    ds_write_b32 v252, v254 offset:352
    s_xor_b32 s36, s35, 0xd000
    s_cbranch_vccnz L_b34
    s_waitcnt vmcnt(4)
L_b34:
    s_waitcnt vmcnt(6)
    buffer_load_dwordx4 v[192:195], v2, s[8:11], s36 offen offset:0 nt
    ds_read_b32 v253, v252 offset:320
    v_mov_b32 v254, 34
    ds_write_b32 v252, v254 offset:352
    s_xor_b32 s36, s35, 0x1f000
    s_cbranch_vccnz L_b35
    s_waitcnt vmcnt(4)
L_b35:
    s_waitcnt vmcnt(6)
    buffer_load_dwordx4 v[196:199], v2, s[8:11], s36 offen offset:256 nt
    s_waitcnt lgkmcnt(0)
    v_cmp_eq_u32 vcc, 1, v253
    v_mov_b32 v254, 35
    ds_write_b32 v252, v254 offset:352
    s_xor_b32 s36, s35, 0x20000
    s_cbranch_vccnz L_b36
    s_waitcnt vmcnt(4)
L_b36:
    s_waitcnt vmcnt(6)
    buffer_load_dwordx4 v[200:203], v2, s[8:11], s36 offen offset:0 nt
    ds_read_b32 v253, v252 offset:320
    v_mov_b32 v254, 36
    ds_write_b32 v252, v254 offset:352
    s_xor_b32 s36, s35, 0x32000
    s_cbranch_vccnz L_b37
    s_waitcnt vmcnt(4)
L_b37:
    s_waitcnt vmcnt(6)
    buffer_load_dwordx4 v[204:207], v2, s[8:11], s36 offen offset:256 nt
    s_waitcnt lgkmcnt(0)
    v_cmp_eq_u32 vcc, 1, v253
    v_mov_b32 v254, 37
    ds_write_b32 v252, v254 offset:352
    s_xor_b32 s36, s35, 0x29000
    s_cbranch_vccnz L_b38
    s_waitcnt vmcnt(4)
L_b38:
    s_waitcnt vmcnt(6)
    buffer_load_dwordx4 v[208:211], v2, s[8:11], s36 offen offset:0 nt
    ds_read_b32 v253, v252 offset:320
    v_mov_b32 v254, 38
    ds_write_b32 v252, v254 offset:352
    s_xor_b32 s36, s35, 0x3b000
    s_cbranch_vccnz L_b39
    s_waitcnt vmcnt(4)
L_b39:
    s_waitcnt vmcnt(6)
    buffer_load_dwordx4 v[212:215], v2, s[8:11], s36 offen offset:256 nt
    s_waitcnt lgkmcnt(0)
    v_cmp_eq_u32 vcc, 1, v253
    v_mov_b32 v254, 39
    ds_write_b32 v252, v254 offset:352
    s_xor_b32 s36, s35, 0x44000
    s_cbranch_vccnz L_b40
    s_waitcnt vmcnt(4)
L_b40:
    s_waitcnt vmcnt(6)
    buffer_load_dwordx4 v[216:219], v2, s[8:11], s36 offen offset:0 nt
    ds_read_b32 v253, v252 offset:320
    v_mov_b32 v254, 40
    ds_write_b32 v252, v254 offset:352
    s_xor_b32 s36, s35, 0x56000
    s_cbranch_vccnz L_b41
    s_waitcnt vmcnt(4)
L_b41:
    s_waitcnt vmcnt(6)
    buffer_load_dwordx4 v[220:223], v2, s[8:11], s36 offen offset:256 nt
    s_waitcnt lgkmcnt(0)
    v_cmp_eq_u32 vcc, 1, v253
    v_mov_b32 v254, 41
    ds_write_b32 v252, v254 offset:352
    s_xor_b32 s36, s35, 0x4d000
    s_cbranch_vccnz L_b42
    s_waitcnt vmcnt(4)
L_b42:
    s_waitcnt vmcnt(6)
    buffer_load_dwordx4 v[224:227], v2, s[8:11], s36 offen offset:0 nt
    ds_read_b32 v253, v252 offset:320
    v_mov_b32 v254, 42
    ds_write_b32 v252, v254 offset:352
    s_xor_b32 s36, s35, 0x5f000
    s_cbranch_vccnz L_b43
    s_waitcnt vmcnt(4)
L_b43:
    s_waitcnt vmcnt(6)
    buffer_load_dwordx4 v[228:231], v2, s[8:11], s36 offen offset:256 nt
    s_waitcnt lgkmcnt(0)
    v_cmp_eq_u32 vcc, 1, v253
    v_mov_b32 v254, 43
    ds_write_b32 v252, v254 offset:352
    s_xor_b32 s36, s35, 0x60000
    s_cbranch_vccnz L_b44
    s_waitcnt vmcnt(4)
L_b44:
    s_waitcnt vmcnt(6)
    buffer_load_dwordx4 v[232:235], v2, s[8:11], s36 offen offset:0 nt
    ds_read_b32 v253, v252 offset:320
    v_mov_b32 v254, 44
    ds_write_b32 v252, v254 offset:352
    s_xor_b32 s36, s35, 0x72000
    s_cbranch_vccnz L_b45
    s_waitcnt vmcnt(4)
L_b45:
    s_waitcnt vmcnt(6)
    buffer_load_dwordx4 v[236:239], v2, s[8:11], s36 offen offset:256 nt
    s_waitcnt lgkmcnt(0)
    v_cmp_eq_u32 vcc, 1, v253
    v_mov_b32 v254, 45
    ds_write_b32 v252, v254 offset:352
    s_barrier
    s_mov_b32 exec_lo, 0xf000f
    s_mov_b32 exec_hi, 0xf000f
    ds_read_b128 v[24:27], v10 offset:0
    s_mov_b32 exec_lo, 0xf000f0
    s_mov_b32 exec_hi, 0xf000f0
    ds_read_b128 v[28:31], v10 offset:0
    s_mov_b32 exec_lo, 0xf000f00
    s_mov_b32 exec_hi, 0xf000f00
    ds_read_b128 v[32:35], v10 offset:0
    s_mov_b32 exec_lo, 0xf000f000
    s_mov_b32 exec_hi, 0xf000f000
    ds_read_b128 v[36:39], v10 offset:0
    s_mov_b64 exec, -1
    s_xor_b32 s36, s35, 0x69000
    s_cbranch_vccnz L_b46
    s_waitcnt vmcnt(4)
L_b46:
    s_waitcnt vmcnt(6)
    buffer_load_dwordx4 v[240:243], v2, s[8:11], s36 offen offset:0 nt
    ds_read_b32 v253, v252 offset:320
    v_mov_b32 v254, 46
    ds_write_b32 v252, v254 offset:352
    s_waitcnt lgkmcnt(0)
    v_mfma_f32_16x16x32_bf16 v[12:15], v[56:59], v[24:27], 0
    v_mfma_f32_16x16x32_bf16 v[12:15], v[60:63], v[28:31], v[12:15]
    v_mfma_f32_16x16x32_bf16 v[12:15], v[64:67], v[32:35], v[12:15]
    v_mfma_f32_16x16x32_bf16 v[12:15], v[68:71], v[36:39], v[12:15]
    v_mfma_f32_16x16x32_bf16 v[16:19], v[72:75], v[24:27], 0
    v_mfma_f32_16x16x32_bf16 v[16:19], v[76:79], v[28:31], v[16:19]
    v_mfma_f32_16x16x32_bf16 v[16:19], v[80:83], v[32:35], v[16:19]
    v_mfma_f32_16x16x32_bf16 v[16:19], v[84:87], v[36:39], v[16:19]
    s_nop 3
    v_mov_b32_dpp v40, v12 quad_perm:[0,0,0,0] row_mask:0xf bank_mask:0xf
    v_add_f32_dpp v40, v13, v40 quad_perm:[1,1,1,1] row_mask:0xf bank_mask:0xf
    v_add_f32_dpp v40, v14, v40 quad_perm:[2,2,2,2] row_mask:0xf bank_mask:0xf
    v_add_f32_dpp v40, v15, v40 quad_perm:[3,3,3,3] row_mask:0xf bank_mask:0xf
    v_mov_b32_dpp v41, v16 quad_perm:[0,0,0,0] row_mask:0xf bank_mask:0xf
    v_add_f32_dpp v41, v17, v41 quad_perm:[1,1,1,1] row_mask:0xf bank_mask:0xf
    v_add_f32_dpp v41, v18, v41 quad_perm:[2,2,2,2] row_mask:0xf bank_mask:0xf
    v_add_f32_dpp v41, v19, v41 quad_perm:[3,3,3,3] row_mask:0xf bank_mask:0xf
    v_max_f32 v8, v40, v41
    s_xor_b32 s36, s35, 0x7b000
    s_cbranch_vccnz L_b47
    s_waitcnt vmcnt(4)
L_b47:
    s_waitcnt vmcnt(6)
    buffer_load_dwordx4 v[244:247], v2, s[8:11], s36 offen offset:256 nt
    s_waitcnt lgkmcnt(0)
    v_cmp_eq_u32 vcc, 1, v253
    v_mov_b32 v254, 47
    ds_write_b32 v252, v254 offset:352
    v_mfma_f32_16x16x32_bf16 v[12:15], v[88:91], v[24:27], 0
    v_mfma_f32_16x16x32_bf16 v[12:15], v[92:95], v[28:31], v[12:15]
    v_mfma_f32_16x16x32_bf16 v[12:15], v[96:99], v[32:35], v[12:15]
    v_mfma_f32_16x16x32_bf16 v[12:15], v[100:103], v[36:39], v[12:15]
    v_mfma_f32_16x16x32_bf16 v[16:19], v[104:107], v[24:27], 0
    v_mfma_f32_16x16x32_bf16 v[16:19], v[108:111], v[28:31], v[16:19]
    v_mfma_f32_16x16x32_bf16 v[16:19], v[112:115], v[32:35], v[16:19]
    v_mfma_f32_16x16x32_bf16 v[16:19], v[116:119], v[36:39], v[16:19]
    s_nop 3
    v_mov_b32_dpp v42, v12 quad_perm:[0,0,0,0] row_mask:0xf bank_mask:0xf
    v_add_f32_dpp v42, v13, v42 quad_perm:[1,1,1,1] row_mask:0xf bank_mask:0xf
    v_add_f32_dpp v42, v14, v42 quad_perm:[2,2,2,2] row_mask:0xf bank_mask:0xf
    v_add_f32_dpp v42, v15, v42 quad_perm:[3,3,3,3] row_mask:0xf bank_mask:0xf
    v_max_f32 v8, v8, v42
    v_mov_b32_dpp v43, v16 quad_perm:[0,0,0,0] row_mask:0xf bank_mask:0xf
    v_add_f32_dpp v43, v17, v43 quad_perm:[1,1,1,1] row_mask:0xf bank_mask:0xf
    v_add_f32_dpp v43, v18, v43 quad_perm:[2,2,2,2] row_mask:0xf bank_mask:0xf
    v_add_f32_dpp v43, v19, v43 quad_perm:[3,3,3,3] row_mask:0xf bank_mask:0xf
    v_max_f32 v8, v8, v43
    s_xor_b32 s36, s35, 0xa4000
    s_cbranch_vccnz L_b48
    s_waitcnt vmcnt(4)
L_b48:
    s_waitcnt vmcnt(6)
    buffer_load_dwordx4 v[248:251], v2, s[8:11], s36 offen offset:0 nt
    ds_read_b32 v253, v252 offset:320
    v_mov_b32 v254, 48
    ds_write_b32 v252, v254 offset:352
    v_mfma_f32_16x16x32_bf16 v[12:15], v[120:123], v[24:27], 0
    v_mfma_f32_16x16x32_bf16 v[12:15], v[124:127], v[28:31], v[12:15]
    v_mfma_f32_16x16x32_bf16 v[12:15], v[128:131], v[32:35], v[12:15]
    v_mfma_f32_16x16x32_bf16 v[12:15], v[132:135], v[36:39], v[12:15]
    v_mfma_f32_16x16x32_bf16 v[16:19], v[136:139], v[24:27], 0
    v_mfma_f32_16x16x32_bf16 v[16:19], v[140:143], v[28:31], v[16:19]
    v_mfma_f32_16x16x32_bf16 v[16:19], v[144:147], v[32:35], v[16:19]
    v_mfma_f32_16x16x32_bf16 v[16:19], v[148:151], v[36:39], v[16:19]
    s_nop 3
    v_mov_b32_dpp v44, v12 quad_perm:[0,0,0,0] row_mask:0xf bank_mask:0xf
    v_add_f32_dpp v44, v13, v44 quad_perm:[1,1,1,1] row_mask:0xf bank_mask:0xf
    v_add_f32_dpp v44, v14, v44 quad_perm:[2,2,2,2] row_mask:0xf bank_mask:0xf
    v_add_f32_dpp v44, v15, v44 quad_perm:[3,3,3,3] row_mask:0xf bank_mask:0xf
    v_max_f32 v8, v8, v44
    v_mov_b32_dpp v45, v16 quad_perm:[0,0,0,0] row_mask:0xf bank_mask:0xf
    v_add_f32_dpp v45, v17, v45 quad_perm:[1,1,1,1] row_mask:0xf bank_mask:0xf
    v_add_f32_dpp v45, v18, v45 quad_perm:[2,2,2,2] row_mask:0xf bank_mask:0xf
    v_add_f32_dpp v45, v19, v45 quad_perm:[3,3,3,3] row_mask:0xf bank_mask:0xf
    v_max_f32 v8, v8, v45
    s_xor_b32 s36, s35, 0xb6000
    s_cbranch_vccnz L_b49
    s_waitcnt vmcnt(4)
L_b49:
    s_waitcnt vmcnt(6)
    buffer_load_dwordx4 v[56:59], v2, s[8:11], s36 offen offset:256 nt
    s_waitcnt lgkmcnt(0)
    v_cmp_eq_u32 vcc, 1, v253
    v_mov_b32 v254, 49
    ds_write_b32 v252, v254 offset:352
    v_mfma_f32_16x16x32_bf16 v[12:15], v[152:155], v[24:27], 0
    v_mfma_f32_16x16x32_bf16 v[12:15], v[156:159], v[28:31], v[12:15]
    v_mfma_f32_16x16x32_bf16 v[12:15], v[160:163], v[32:35], v[12:15]
    v_mfma_f32_16x16x32_bf16 v[12:15], v[164:167], v[36:39], v[12:15]
    v_mfma_f32_16x16x32_bf16 v[16:19], v[168:171], v[24:27], 0
    v_mfma_f32_16x16x32_bf16 v[16:19], v[172:175], v[28:31], v[16:19]
    v_mfma_f32_16x16x32_bf16 v[16:19], v[176:179], v[32:35], v[16:19]
    v_mfma_f32_16x16x32_bf16 v[16:19], v[180:183], v[36:39], v[16:19]
    s_nop 3
    v_mov_b32_dpp v46, v12 quad_perm:[0,0,0,0] row_mask:0xf bank_mask:0xf
    v_add_f32_dpp v46, v13, v46 quad_perm:[1,1,1,1] row_mask:0xf bank_mask:0xf
    v_add_f32_dpp v46, v14, v46 quad_perm:[2,2,2,2] row_mask:0xf bank_mask:0xf
    v_add_f32_dpp v46, v15, v46 quad_perm:[3,3,3,3] row_mask:0xf bank_mask:0xf
    v_max_f32 v8, v8, v46
    v_mov_b32_dpp v47, v16 quad_perm:[0,0,0,0] row_mask:0xf bank_mask:0xf
    v_add_f32_dpp v47, v17, v47 quad_perm:[1,1,1,1] row_mask:0xf bank_mask:0xf
    v_add_f32_dpp v47, v18, v47 quad_perm:[2,2,2,2] row_mask:0xf bank_mask:0xf
    v_add_f32_dpp v47, v19, v47 quad_perm:[3,3,3,3] row_mask:0xf bank_mask:0xf
    v_max_f32 v8, v8, v47
    s_xor_b32 s36, s35, 0xad000
    s_cbranch_vccnz L_b50
    s_waitcnt vmcnt(4)
L_b50:
    s_waitcnt vmcnt(6)
    buffer_load_dwordx4 v[60:63], v2, s[8:11], s36 offen offset:0 nt
    ds_read_b32 v253, v252 offset:320
    v_mov_b32 v254, 50
    ds_write_b32 v252, v254 offset:352
    v_mfma_f32_16x16x32_bf16 v[12:15], v[184:187], v[24:27], 0
    v_mfma_f32_16x16x32_bf16 v[12:15], v[188:191], v[28:31], v[12:15]
    v_mfma_f32_16x16x32_bf16 v[12:15], v[192:195], v[32:35], v[12:15]
    v_mfma_f32_16x16x32_bf16 v[12:15], v[196:199], v[36:39], v[12:15]
    v_mfma_f32_16x16x32_bf16 v[16:19], v[200:203], v[24:27], 0
    v_mfma_f32_16x16x32_bf16 v[16:19], v[204:207], v[28:31], v[16:19]
    v_mfma_f32_16x16x32_bf16 v[16:19], v[208:211], v[32:35], v[16:19]
    v_mfma_f32_16x16x32_bf16 v[16:19], v[212:215], v[36:39], v[16:19]
    s_nop 3
    v_mov_b32_dpp v48, v12 quad_perm:[0,0,0,0] row_mask:0xf bank_mask:0xf
    v_add_f32_dpp v48, v13, v48 quad_perm:[1,1,1,1] row_mask:0xf bank_mask:0xf
    v_add_f32_dpp v48, v14, v48 quad_perm:[2,2,2,2] row_mask:0xf bank_mask:0xf
    v_add_f32_dpp v48, v15, v48 quad_perm:[3,3,3,3] row_mask:0xf bank_mask:0xf
    v_max_f32 v8, v8, v48
    v_mov_b32_dpp v49, v16 quad_perm:[0,0,0,0] row_mask:0xf bank_mask:0xf
    v_add_f32_dpp v49, v17, v49 quad_perm:[1,1,1,1] row_mask:0xf bank_mask:0xf
    v_add_f32_dpp v49, v18, v49 quad_perm:[2,2,2,2] row_mask:0xf bank_mask:0xf
    v_add_f32_dpp v49, v19, v49 quad_perm:[3,3,3,3] row_mask:0xf bank_mask:0xf
    v_max_f32 v8, v8, v49
    s_xor_b32 s36, s35, 0xbf000
    s_cbranch_vccnz L_b51
    s_waitcnt vmcnt(4)
L_b51:
    s_waitcnt vmcnt(6)
    buffer_load_dwordx4 v[64:67], v2, s[8:11], s36 offen offset:256 nt
    s_waitcnt lgkmcnt(0)
    v_cmp_eq_u32 vcc, 1, v253
    v_mov_b32 v254, 51
    ds_write_b32 v252, v254 offset:352
    v_mfma_f32_16x16x32_bf16 v[12:15], v[216:219], v[24:27], 0
    v_mfma_f32_16x16x32_bf16 v[12:15], v[220:223], v[28:31], v[12:15]
    v_mfma_f32_16x16x32_bf16 v[12:15], v[224:227], v[32:35], v[12:15]
    v_mfma_f32_16x16x32_bf16 v[12:15], v[228:231], v[36:39], v[12:15]
    s_nop 7
    v_mov_b32_dpp v50, v12 quad_perm:[0,0,0,0] row_mask:0xf bank_mask:0xf
    v_add_f32_dpp v50, v13, v50 quad_perm:[1,1,1,1] row_mask:0xf bank_mask:0xf
    v_add_f32_dpp v50, v14, v50 quad_perm:[2,2,2,2] row_mask:0xf bank_mask:0xf
    v_add_f32_dpp v50, v15, v50 quad_perm:[3,3,3,3] row_mask:0xf bank_mask:0xf
    v_max_f32 v8, v8, v50
    s_xor_b32 s36, s35, 0x80000
    s_cbranch_vccnz L_b52
    s_waitcnt vmcnt(4)
L_b52:
    s_waitcnt vmcnt(6)
    buffer_load_dwordx4 v[68:71], v2, s[8:11], s36 offen offset:0 nt
    ds_read_b32 v253, v252 offset:320
    v_mov_b32 v254, 52
    ds_write_b32 v252, v254 offset:352
    s_xor_b32 s36, s35, 0x92000
    s_cbranch_vccnz L_b53
    s_waitcnt vmcnt(4)
L_b53:
    s_waitcnt vmcnt(6)
    buffer_load_dwordx4 v[72:75], v2, s[8:11], s36 offen offset:256 nt
    s_waitcnt lgkmcnt(0)
    v_cmp_eq_u32 vcc, 1, v253
    v_mov_b32 v254, 53
    ds_write_b32 v252, v254 offset:352
    s_xor_b32 s36, s35, 0x89000
    s_cbranch_vccnz L_b54
    s_waitcnt vmcnt(4)
L_b54:
    s_waitcnt vmcnt(6)
    buffer_load_dwordx4 v[76:79], v2, s[8:11], s36 offen offset:0 nt
    ds_read_b32 v253, v252 offset:320
    s_branch L_pg1_skip
L_pg1:
    s_branch L_pg2
L_pg1_skip:
    v_mov_b32 v254, 54
    ds_write_b32 v252, v254 offset:352
    v_mfma_f32_16x16x32_bf16 v[16:19], v[232:235], v[24:27], 0
    v_mfma_f32_16x16x32_bf16 v[16:19], v[236:239], v[28:31], v[16:19]
    v_mfma_f32_16x16x32_bf16 v[16:19], v[240:243], v[32:35], v[16:19]
    v_mfma_f32_16x16x32_bf16 v[16:19], v[244:247], v[36:39], v[16:19]
    s_nop 7
    v_mov_b32_dpp v51, v16 quad_perm:[0,0,0,0] row_mask:0xf bank_mask:0xf
    v_add_f32_dpp v51, v17, v51 quad_perm:[1,1,1,1] row_mask:0xf bank_mask:0xf
    v_add_f32_dpp v51, v18, v51 quad_perm:[2,2,2,2] row_mask:0xf bank_mask:0xf
    v_add_f32_dpp v51, v19, v51 quad_perm:[3,3,3,3] row_mask:0xf bank_mask:0xf
    v_max_f32 v8, v8, v51
    s_xor_b32 s36, s35, 0x9b000
    s_cbranch_vccnz L_b55
    s_waitcnt vmcnt(4)
L_b55:
    s_waitcnt vmcnt(6)
    buffer_load_dwordx4 v[80:83], v2, s[8:11], s36 offen offset:256 nt
    s_waitcnt lgkmcnt(0)
    v_cmp_eq_u32 vcc, 1, v253
    v_mov_b32 v254, 55
    ds_write_b32 v252, v254 offset:352
    s_xor_b32 s36, s35, 0xe4000
    s_cbranch_vccnz L_b56
    s_waitcnt vmcnt(4)
L_b56:
    s_waitcnt vmcnt(6)
    buffer_load_dwordx4 v[84:87], v2, s[8:11], s36 offen offset:0 nt
    ds_read_b32 v253, v252 offset:320
    v_mov_b32 v254, 56
    ds_write_b32 v252, v254 offset:352
    s_xor_b32 s36, s35, 0xf6000
    s_cbranch_vccnz L_b57
    s_waitcnt vmcnt(4)
L_b57:
    s_waitcnt vmcnt(6)
    buffer_load_dwordx4 v[88:91], v2, s[8:11], s36 offen offset:256 nt
    s_waitcnt lgkmcnt(0)
    v_cmp_eq_u32 vcc, 1, v253
    v_mov_b32 v254, 57
    ds_write_b32 v252, v254 offset:352
    s_xor_b32 s36, s35, 0xed000
    s_cbranch_vccnz L_b58
    s_waitcnt vmcnt(4)
L_b58:
    s_waitcnt vmcnt(6)
    buffer_load_dwordx4 v[92:95], v2, s[8:11], s36 offen offset:0 nt
    ds_read_b32 v253, v252 offset:320
    v_mov_b32 v254, 58
    ds_write_b32 v252, v254 offset:352
    v_mfma_f32_16x16x32_bf16 v[12:15], v[248:251], v[24:27], 0
    v_mfma_f32_16x16x32_bf16 v[12:15], v[56:59], v[28:31], v[12:15]
    v_mfma_f32_16x16x32_bf16 v[12:15], v[60:63], v[32:35], v[12:15]
    v_mfma_f32_16x16x32_bf16 v[12:15], v[64:67], v[36:39], v[12:15]
    s_nop 7
    v_mov_b32_dpp v52, v12 quad_perm:[0,0,0,0] row_mask:0xf bank_mask:0xf
    v_add_f32_dpp v52, v13, v52 quad_perm:[1,1,1,1] row_mask:0xf bank_mask:0xf
    v_add_f32_dpp v52, v14, v52 quad_perm:[2,2,2,2] row_mask:0xf bank_mask:0xf
    v_add_f32_dpp v52, v15, v52 quad_perm:[3,3,3,3] row_mask:0xf bank_mask:0xf
    v_max_f32 v8, v8, v52
    s_xor_b32 s36, s35, 0xff000
    s_cbranch_vccnz L_b59
    s_waitcnt vmcnt(4)
L_b59:
    s_waitcnt vmcnt(6)
    buffer_load_dwordx4 v[96:99], v2, s[8:11], s36 offen offset:256 nt
    s_waitcnt lgkmcnt(0)
    v_cmp_eq_u32 vcc, 1, v253
    v_mov_b32 v254, 59
    ds_write_b32 v252, v254 offset:352
    s_xor_b32 s36, s35, 0xc0000
    s_cbranch_vccnz L_b60
    s_waitcnt vmcnt(4)
L_b60:
    s_waitcnt vmcnt(6)
    buffer_load_dwordx4 v[100:103], v2, s[8:11], s36 offen offset:0 nt
    ds_read_b32 v253, v252 offset:320
    v_mov_b32 v254, 60
    ds_write_b32 v252, v254 offset:352
    s_xor_b32 s36, s35, 0xd2000
    s_cbranch_vccnz L_b61
    s_waitcnt vmcnt(4)
L_b61:
    s_waitcnt vmcnt(6)
    buffer_load_dwordx4 v[104:107], v2, s[8:11], s36 offen offset:256 nt
    s_waitcnt lgkmcnt(0)
    v_cmp_eq_u32 vcc, 1, v253
    v_mov_b32 v254, 61
    ds_write_b32 v252, v254 offset:352
    s_xor_b32 s36, s35, 0xc9000
    s_cbranch_vccnz L_b62
    s_waitcnt vmcnt(4)
L_b62:
    s_waitcnt vmcnt(6)
    buffer_load_dwordx4 v[108:111], v2, s[8:11], s36 offen offset:0 nt
    ds_read_b32 v253, v252 offset:320
    v_mov_b32 v254, 62
    ds_write_b32 v252, v254 offset:352
    v_mfma_f32_16x16x32_bf16 v[16:19], v[68:71], v[24:27], 0
    v_mfma_f32_16x16x32_bf16 v[16:19], v[72:75], v[28:31], v[16:19]
    v_mfma_f32_16x16x32_bf16 v[16:19], v[76:79], v[32:35], v[16:19]
    v_mfma_f32_16x16x32_bf16 v[16:19], v[80:83], v[36:39], v[16:19]
    s_nop 7
    v_mov_b32_dpp v53, v16 quad_perm:[0,0,0,0] row_mask:0xf bank_mask:0xf
    v_add_f32_dpp v53, v17, v53 quad_perm:[1,1,1,1] row_mask:0xf bank_mask:0xf
    v_add_f32_dpp v53, v18, v53 quad_perm:[2,2,2,2] row_mask:0xf bank_mask:0xf
    v_add_f32_dpp v53, v19, v53 quad_perm:[3,3,3,3] row_mask:0xf bank_mask:0xf
    v_max_f32 v8, v8, v53
    s_xor_b32 s36, s35, 0xdb000
    s_cbranch_vccnz L_b63
    s_waitcnt vmcnt(4)
L_b63:
    s_waitcnt vmcnt(6)
    buffer_load_dwordx4 v[112:115], v2, s[8:11], s36 offen offset:256 nt
    s_waitcnt lgkmcnt(0)
    v_cmp_eq_u32 vcc, 1, v253
    v_mov_b32 v254, 63
    ds_write_b32 v252, v254 offset:352
    s_cbranch_vccnz L_b64
    s_waitcnt vmcnt(4)
L_b64:
    s_waitcnt vmcnt(6)
    buffer_load_dwordx4 v[116:119], v3, s[12:15], s35 offen offset:0 nt
    ds_read_b32 v253, v252 offset:320
    v_mov_b32 v254, 64
    ds_write_b32 v252, v254 offset:352
    s_xor_b32 s36, s35, 0x12000
    s_cbranch_vccnz L_b65
    s_waitcnt vmcnt(4)
L_b65:
    s_waitcnt vmcnt(6)
    buffer_load_dwordx4 v[120:123], v3, s[12:15], s36 offen offset:256 nt
    s_waitcnt lgkmcnt(0)
    v_cmp_eq_u32 vcc, 1, v253
    v_mov_b32 v254, 65
    ds_write_b32 v252, v254 offset:352
    s_xor_b32 s36, s35, 0x9000
    s_cbranch_vccnz L_b66
    s_waitcnt vmcnt(4)
L_b66:
    s_waitcnt vmcnt(6)
    buffer_load_dwordx4 v[124:127], v3, s[12:15], s36 offen offset:0 nt
    ds_read_b32 v253, v252 offset:320
    v_mov_b32 v254, 66
    ds_write_b32 v252, v254 offset:352
    v_mfma_f32_16x16x32_bf16 v[12:15], v[84:87], v[24:27], 0
    v_mfma_f32_16x16x32_bf16 v[12:15], v[88:91], v[28:31], v[12:15]
    v_mfma_f32_16x16x32_bf16 v[12:15], v[92:95], v[32:35], v[12:15]
    v_mfma_f32_16x16x32_bf16 v[12:15], v[96:99], v[36:39], v[12:15]
    s_nop 7
    v_mov_b32_dpp v54, v12 quad_perm:[0,0,0,0] row_mask:0xf bank_mask:0xf
    v_add_f32_dpp v54, v13, v54 quad_perm:[1,1,1,1] row_mask:0xf bank_mask:0xf
    v_add_f32_dpp v54, v14, v54 quad_perm:[2,2,2,2] row_mask:0xf bank_mask:0xf
    v_add_f32_dpp v54, v15, v54 quad_perm:[3,3,3,3] row_mask:0xf bank_mask:0xf
    v_max_f32 v8, v8, v54
    s_xor_b32 s36, s35, 0x1b000
    s_cbranch_vccnz L_b67
    s_waitcnt vmcnt(4)
L_b67:
    s_waitcnt vmcnt(6)
    buffer_load_dwordx4 v[128:131], v3, s[12:15], s36 offen offset:256 nt
    s_waitcnt lgkmcnt(0)
    v_cmp_eq_u32 vcc, 1, v253
    v_mov_b32 v254, 67
    ds_write_b32 v252, v254 offset:352
    s_xor_b32 s36, s35, 0x24000
    s_cbranch_vccnz L_b68
    s_waitcnt vmcnt(4)
L_b68:
    s_waitcnt vmcnt(6)
    buffer_load_dwordx4 v[132:135], v3, s[12:15], s36 offen offset:0 nt
    ds_read_b32 v253, v252 offset:320
    v_mov_b32 v254, 68
    ds_write_b32 v252, v254 offset:352
    s_xor_b32 s36, s35, 0x36000
    s_cbranch_vccnz L_b69
    s_waitcnt vmcnt(4)
L_b69:
    s_waitcnt vmcnt(6)
    buffer_load_dwordx4 v[136:139], v3, s[12:15], s36 offen offset:256 nt
    s_waitcnt lgkmcnt(0)
    v_cmp_eq_u32 vcc, 1, v253
    v_mov_b32 v254, 69
    ds_write_b32 v252, v254 offset:352
    s_xor_b32 s36, s35, 0x2d000
    s_cbranch_vccnz L_b70
    s_waitcnt vmcnt(4)
L_b70:
    s_waitcnt vmcnt(6)
    buffer_load_dwordx4 v[140:143], v3, s[12:15], s36 offen offset:0 nt
    ds_read_b32 v253, v252 offset:320
    v_mov_b32 v254, 70
    ds_write_b32 v252, v254 offset:352
    v_mfma_f32_16x16x32_bf16 v[16:19], v[100:103], v[24:27], 0
    v_mfma_f32_16x16x32_bf16 v[16:19], v[104:107], v[28:31], v[16:19]
    v_mfma_f32_16x16x32_bf16 v[16:19], v[108:111], v[32:35], v[16:19]
    v_mfma_f32_16x16x32_bf16 v[16:19], v[112:115], v[36:39], v[16:19]
    s_nop 7
    v_mov_b32_dpp v55, v16 quad_perm:[0,0,0,0] row_mask:0xf bank_mask:0xf
    v_add_f32_dpp v55, v17, v55 quad_perm:[1,1,1,1] row_mask:0xf bank_mask:0xf
    v_add_f32_dpp v55, v18, v55 quad_perm:[2,2,2,2] row_mask:0xf bank_mask:0xf
    v_add_f32_dpp v55, v19, v55 quad_perm:[3,3,3,3] row_mask:0xf bank_mask:0xf
    v_max_f32 v8, v8, v55
    s_xor_b32 s36, s35, 0x3f000
    buffer_load_dwordx4 v[144:147], v3, s[12:15], s36 offen offset:256 nt
    s_waitcnt lgkmcnt(0)
    v_cmp_eq_u32 vcc, 1, v253
    v_mov_b32 v254, 71
    ds_write_b32 v252, v254 offset:352
    v_max_f32_dpp v8, v8, v8 row_ror:4 row_mask:0xf bank_mask:0xf
    s_nop 1
    v_max_f32_dpp v8, v8, v8 row_ror:8 row_mask:0xf bank_mask:0xf
    v_mov_b32 v10, v8
    s_nop 1
    v_permlane16_swap_b32 v8, v10
    v_max_f32 v8, v8, v10
    v_mov_b32 v10, v8
    s_nop 1
    v_permlane32_swap_b32 v8, v10
    v_max_f32 v8, v8, v10
    v_mul_f32 v12, s40, v8
    v_fma_f32 v40, v40, s40, -v12
    v_fma_f32 v41, v41, s40, -v12
    v_fma_f32 v42, v42, s40, -v12
    v_fma_f32 v43, v43, s40, -v12
    v_fma_f32 v44, v44, s40, -v12
    v_fma_f32 v45, v45, s40, -v12
    v_fma_f32 v46, v46, s40, -v12
    v_fma_f32 v47, v47, s40, -v12
    v_fma_f32 v48, v48, s40, -v12
    v_fma_f32 v49, v49, s40, -v12
    v_fma_f32 v50, v50, s40, -v12
    v_fma_f32 v51, v51, s40, -v12
    v_fma_f32 v52, v52, s40, -v12
    v_fma_f32 v53, v53, s40, -v12
    v_fma_f32 v54, v54, s40, -v12
    v_fma_f32 v55, v55, s40, -v12
    v_exp_f32 v40, v40
    v_exp_f32 v41, v41
    v_exp_f32 v42, v42
    v_exp_f32 v43, v43
    v_exp_f32 v44, v44
    v_exp_f32 v45, v45
    v_exp_f32 v46, v46
    v_exp_f32 v47, v47
    v_exp_f32 v48, v48
    v_exp_f32 v49, v49
    v_exp_f32 v50, v50
    v_exp_f32 v51, v51
    v_exp_f32 v52, v52
    v_exp_f32 v53, v53
    v_exp_f32 v54, v54
    v_exp_f32 v55, v55
    s_xor_b32 s36, s35, 0x40000
    buffer_load_dwordx4 v[148:151], v3, s[12:15], s36 offen offset:0 nt
    ds_read_b32 v253, v252 offset:320
    v_mov_b32 v254, 72
    ds_write_b32 v252, v254 offset:352
    v_add_f32 v13, v40, v41
    v_add_f32 v14, v42, v43
    v_add_f32 v13, v13, v44
    v_add_f32 v14, v14, v45
    v_add_f32 v13, v13, v46
    v_add_f32 v14, v14, v47
    v_add_f32 v13, v13, v48
    v_add_f32 v14, v14, v49
    v_add_f32 v13, v13, v50
    v_add_f32 v14, v14, v51
    v_add_f32 v13, v13, v52
    v_add_f32 v14, v14, v53
    v_add_f32 v13, v13, v54
    v_add_f32 v14, v14, v55
    v_add_f32 v13, v13, v14
    s_nop 1
    v_add_f32_dpp v13, v13, v13 row_ror:4 row_mask:0xf bank_mask:0xf
    s_nop 1
    v_add_f32_dpp v13, v13, v13 row_ror:8 row_mask:0xf bank_mask:0xf
    v_mov_b32 v14, v13
    s_nop 1
    v_permlane16_swap_b32 v13, v14
    v_add_f32 v13, v13, v14
    v_mov_b32 v14, v13
    s_nop 1
    v_permlane32_swap_b32 v13, v14
    v_add_f32 v13, v13, v14
    v_lshlrev_b32 v14, 1, v252
    v_min_u32 v12, -2, v12
    v_min_u32 v13, -2, v13
    s_mov_b64 exec, 1
    ds_write_b64 v14, v[12:13] offset:256
    s_mov_b64 exec, -1
    v_cvt_pk_bf16_f32 v40, v40, v40
    s_nop 1
    v_and_b32_dpp v16, v40, v4 row_newbcast:0 row_mask:0xf bank_mask:0xf
    v_and_b32_dpp v17, v40, v5 row_newbcast:0 row_mask:0xf bank_mask:0xf
    v_and_b32_dpp v18, v40, v6 row_newbcast:0 row_mask:0xf bank_mask:0xf
    v_and_b32_dpp v19, v40, v7 row_newbcast:0 row_mask:0xf bank_mask:0xf
    s_waitcnt vmcnt(8)
    s_nop 0
    v_mfma_f32_16x16x32_bf16 v[12:15], v[16:19], v[116:119], 0
    v_and_b32_dpp v20, v40, v4 row_newbcast:4 row_mask:0xf bank_mask:0xf
    v_and_b32_dpp v21, v40, v5 row_newbcast:4 row_mask:0xf bank_mask:0xf
    v_and_b32_dpp v22, v40, v6 row_newbcast:4 row_mask:0xf bank_mask:0xf
    v_and_b32_dpp v23, v40, v7 row_newbcast:4 row_mask:0xf bank_mask:0xf
    s_waitcnt vmcnt(7)
    s_nop 0
    v_mfma_f32_16x16x32_bf16 v[12:15], v[20:23], v[120:123], v[12:15]
    v_and_b32_dpp v16, v40, v4 row_newbcast:8 row_mask:0xf bank_mask:0xf
    v_and_b32_dpp v17, v40, v5 row_newbcast:8 row_mask:0xf bank_mask:0xf
    v_and_b32_dpp v18, v40, v6 row_newbcast:8 row_mask:0xf bank_mask:0xf
    v_and_b32_dpp v19, v40, v7 row_newbcast:8 row_mask:0xf bank_mask:0xf
    s_xor_b32 s36, s35, 0x52000
    s_cbranch_vccnz L_b73
    s_waitcnt vmcnt(4)
L_b73:
    s_waitcnt vmcnt(6)
    buffer_load_dwordx4 v[152:155], v3, s[12:15], s36 offen offset:256 nt
    s_waitcnt lgkmcnt(0)
    v_cmp_eq_u32 vcc, 1, v253
    v_mov_b32 v254, 73
    ds_write_b32 v252, v254 offset:352
    v_mfma_f32_16x16x32_bf16 v[12:15], v[16:19], v[124:127], v[12:15]
    v_and_b32_dpp v20, v40, v4 row_newbcast:12 row_mask:0xf bank_mask:0xf
    v_and_b32_dpp v21, v40, v5 row_newbcast:12 row_mask:0xf bank_mask:0xf
    v_and_b32_dpp v22, v40, v6 row_newbcast:12 row_mask:0xf bank_mask:0xf
    v_and_b32_dpp v23, v40, v7 row_newbcast:12 row_mask:0xf bank_mask:0xf
    s_xor_b32 s36, s35, 0x49000
    s_cbranch_vccnz L_b74
    s_waitcnt vmcnt(4)
L_b74:
    s_waitcnt vmcnt(6)
    buffer_load_dwordx4 v[156:159], v3, s[12:15], s36 offen offset:0 nt
    ds_read_b32 v253, v252 offset:320
    v_mov_b32 v254, 74
    ds_write_b32 v252, v254 offset:352
    v_mfma_f32_16x16x32_bf16 v[12:15], v[20:23], v[128:131], v[12:15]
    v_cvt_pk_bf16_f32 v41, v41, v41
    s_nop 1
    v_and_b32_dpp v16, v41, v4 row_newbcast:0 row_mask:0xf bank_mask:0xf
    v_and_b32_dpp v17, v41, v5 row_newbcast:0 row_mask:0xf bank_mask:0xf
    v_and_b32_dpp v18, v41, v6 row_newbcast:0 row_mask:0xf bank_mask:0xf
    v_and_b32_dpp v19, v41, v7 row_newbcast:0 row_mask:0xf bank_mask:0xf
    s_xor_b32 s36, s35, 0x5b000
    s_cbranch_vccnz L_b75
    s_waitcnt vmcnt(4)
L_b75:
    s_waitcnt vmcnt(6)
    buffer_load_dwordx4 v[160:163], v3, s[12:15], s36 offen offset:256 nt
    s_waitcnt lgkmcnt(0)
    v_cmp_eq_u32 vcc, 1, v253
    v_mov_b32 v254, 75
    ds_write_b32 v252, v254 offset:352
    v_mfma_f32_16x16x32_bf16 v[12:15], v[16:19], v[132:135], v[12:15]
    s_lshl_b32 s43, s32, 10
    s_addk_i32 s43, 0x1000
    s_lshl_b32 s44, s33, 4
    s_branch L_pg2_skip
L_pg2:
    s_branch L_pg3
L_pg2_skip:
    s_add_u32 s44, s44, s32
    s_mul_i32 s44, s44, 10240
    s_lshl_b32 s37, s34, 7
    s_add_u32 s44, s44, s37
    s_and_b32 s37, s32, 2
    s_lshl_b32 s37, s37, 1
    v_lshrrev_b32 v10, 3, v1
    v_and_b32 v11, 2, v10
    v_xor_b32 v11, v1, v11
    v_xor_b32 v11, s37, v11
    v_and_b32 v11, 7, v11
    v_mul_u32_u24 v10, 1280, v10
    v_lshl_add_u32 v24, v11, 4, v10
    v_lshrrev_b32 v10, 4, v1
    v_bfe_u32 v11, v1, 2, 2
    v_lshl_add_u32 v30, v10, 4, v11
    v_lshlrev_b32 v30, 7, v30
    v_bfe_u32 v11, v1, 3, 2
    v_xor_b32 v11, s32, v11
    v_lshl_add_u32 v30, v11, 5, v30
    v_and_b32 v11, 3, v1
    v_lshl_add_u32 v30, v11, 3, v30
    v_and_b32_dpp v20, v41, v4 row_newbcast:4 row_mask:0xf bank_mask:0xf
    v_and_b32_dpp v21, v41, v5 row_newbcast:4 row_mask:0xf bank_mask:0xf
    v_and_b32_dpp v22, v41, v6 row_newbcast:4 row_mask:0xf bank_mask:0xf
    v_and_b32_dpp v23, v41, v7 row_newbcast:4 row_mask:0xf bank_mask:0xf
    s_xor_b32 s36, s35, 0x64000
    s_cbranch_vccnz L_b76
    s_waitcnt vmcnt(4)
L_b76:
    s_waitcnt vmcnt(6)
    buffer_load_dwordx4 v[164:167], v3, s[12:15], s36 offen offset:0 nt
    ds_read_b32 v253, v252 offset:320
    v_mov_b32 v254, 76
    ds_write_b32 v252, v254 offset:352
    v_mfma_f32_16x16x32_bf16 v[12:15], v[20:23], v[136:139], v[12:15]
    v_and_b32_dpp v16, v41, v4 row_newbcast:8 row_mask:0xf bank_mask:0xf
    v_and_b32_dpp v17, v41, v5 row_newbcast:8 row_mask:0xf bank_mask:0xf
    v_and_b32_dpp v18, v41, v6 row_newbcast:8 row_mask:0xf bank_mask:0xf
    v_and_b32_dpp v19, v41, v7 row_newbcast:8 row_mask:0xf bank_mask:0xf
    s_xor_b32 s36, s35, 0x76000
    s_cbranch_vccnz L_b77
    s_waitcnt vmcnt(4)
L_b77:
    s_waitcnt vmcnt(6)
    buffer_load_dwordx4 v[168:171], v3, s[12:15], s36 offen offset:256 nt
    s_waitcnt lgkmcnt(0)
    v_cmp_eq_u32 vcc, 1, v253
    v_mov_b32 v254, 77
    ds_write_b32 v252, v254 offset:352
    v_mfma_f32_16x16x32_bf16 v[12:15], v[16:19], v[140:143], v[12:15]
    s_lshl_b32 s46, s34, 2
    s_add_u32 s46, s46, s32
    v_lshrrev_b32 v10, 4, v1
    v_and_b32 v11, 15, v1
    v_lshlrev_b32 v32, 8, v10
    v_lshl_add_u32 v32, v11, 2, v32
    v_and_b32 v33, 1, v10
    v_mul_u32_u24 v33, 1280, v33
    v_lshl_add_u32 v33, v11, 1, v33
    v_lshlrev_b32 v31, 4, v1
    v_mov_b32 v34, 1.0
    s_lshl_b32 s3, s46, 5
    s_lshl_b32 s47, s46, 10
    s_add_u32 s47, s47, 0x80000
    s_lshl_b32 s48, s33, 12
    s_mov_b32 s49, 0x41f80000
    s_mov_b32 s50, 0x00ff00ff
    s_mov_b32 s51, 0xff00ff00
    s_mov_b32 s52, 0x01ff01ff
    s_mov_b32 s53, 0xff01ff01
    v_and_b32_dpp v20, v41, v4 row_newbcast:12 row_mask:0xf bank_mask:0xf
    v_and_b32_dpp v21, v41, v5 row_newbcast:12 row_mask:0xf bank_mask:0xf
    v_and_b32_dpp v22, v41, v6 row_newbcast:12 row_mask:0xf bank_mask:0xf
    v_and_b32_dpp v23, v41, v7 row_newbcast:12 row_mask:0xf bank_mask:0xf
    s_xor_b32 s36, s35, 0x6d000
    s_cbranch_vccnz L_b78
    s_waitcnt vmcnt(4)
L_b78:
    s_waitcnt vmcnt(6)
    buffer_load_dwordx4 v[172:175], v3, s[12:15], s36 offen offset:0 nt
    ds_read_b32 v253, v252 offset:320
    v_mov_b32 v254, 78
    ds_write_b32 v252, v254 offset:352
    v_mfma_f32_16x16x32_bf16 v[12:15], v[20:23], v[144:147], v[12:15]
    v_cvt_pk_bf16_f32 v42, v42, v42
    s_nop 1
    v_and_b32_dpp v16, v42, v4 row_newbcast:0 row_mask:0xf bank_mask:0xf
    v_and_b32_dpp v17, v42, v5 row_newbcast:0 row_mask:0xf bank_mask:0xf
    v_and_b32_dpp v18, v42, v6 row_newbcast:0 row_mask:0xf bank_mask:0xf
    v_and_b32_dpp v19, v42, v7 row_newbcast:0 row_mask:0xf bank_mask:0xf
    s_xor_b32 s36, s35, 0x7f000
    s_cbranch_vccnz L_b79
    s_waitcnt vmcnt(4)
L_b79:
    s_waitcnt vmcnt(6)
    buffer_load_dwordx4 v[176:179], v3, s[12:15], s36 offen offset:256 nt
    s_waitcnt lgkmcnt(0)
    v_cmp_eq_u32 vcc, 1, v253
    v_mov_b32 v254, 79
    ds_write_b32 v252, v254 offset:352
    v_mfma_f32_16x16x32_bf16 v[12:15], v[16:19], v[148:151], v[12:15]
    v_and_b32_dpp v20, v42, v4 row_newbcast:4 row_mask:0xf bank_mask:0xf
    v_and_b32_dpp v21, v42, v5 row_newbcast:4 row_mask:0xf bank_mask:0xf
    v_and_b32_dpp v22, v42, v6 row_newbcast:4 row_mask:0xf bank_mask:0xf
    v_and_b32_dpp v23, v42, v7 row_newbcast:4 row_mask:0xf bank_mask:0xf
    s_xor_b32 s36, s35, 0xa0000
    s_cbranch_vccnz L_b80
    s_waitcnt vmcnt(4)
L_b80:
    s_waitcnt vmcnt(6)
    buffer_load_dwordx4 v[180:183], v3, s[12:15], s36 offen offset:0 nt
    ds_read_b32 v253, v252 offset:320
    v_mov_b32 v254, 80
    ds_write_b32 v252, v254 offset:352
    v_mfma_f32_16x16x32_bf16 v[12:15], v[20:23], v[152:155], v[12:15]
    v_and_b32_dpp v16, v42, v4 row_newbcast:8 row_mask:0xf bank_mask:0xf
    v_and_b32_dpp v17, v42, v5 row_newbcast:8 row_mask:0xf bank_mask:0xf
    v_and_b32_dpp v18, v42, v6 row_newbcast:8 row_mask:0xf bank_mask:0xf
    v_and_b32_dpp v19, v42, v7 row_newbcast:8 row_mask:0xf bank_mask:0xf
    s_xor_b32 s36, s35, 0xb2000
    s_cbranch_vccnz L_b81
    s_waitcnt vmcnt(4)
L_b81:
    s_waitcnt vmcnt(6)
    buffer_load_dwordx4 v[184:187], v3, s[12:15], s36 offen offset:256 nt
    s_waitcnt lgkmcnt(0)
    v_cmp_eq_u32 vcc, 1, v253
    v_mov_b32 v254, 81
    ds_write_b32 v252, v254 offset:352
    v_mfma_f32_16x16x32_bf16 v[12:15], v[16:19], v[156:159], v[12:15]
    v_and_b32_dpp v20, v42, v4 row_newbcast:12 row_mask:0xf bank_mask:0xf
    v_and_b32_dpp v21, v42, v5 row_newbcast:12 row_mask:0xf bank_mask:0xf
    v_and_b32_dpp v22, v42, v6 row_newbcast:12 row_mask:0xf bank_mask:0xf
    v_and_b32_dpp v23, v42, v7 row_newbcast:12 row_mask:0xf bank_mask:0xf
    s_xor_b32 s36, s35, 0xa9000
    s_cbranch_vccnz L_b82
    s_waitcnt vmcnt(4)
L_b82:
    s_waitcnt vmcnt(6)
    buffer_load_dwordx4 v[188:191], v3, s[12:15], s36 offen offset:0 nt
    ds_read_b32 v253, v252 offset:320
    v_mov_b32 v254, 82
    ds_write_b32 v252, v254 offset:352
    v_mfma_f32_16x16x32_bf16 v[12:15], v[20:23], v[160:163], v[12:15]
    v_cvt_pk_bf16_f32 v43, v43, v43
    s_nop 1
    v_and_b32_dpp v16, v43, v4 row_newbcast:0 row_mask:0xf bank_mask:0xf
    v_and_b32_dpp v17, v43, v5 row_newbcast:0 row_mask:0xf bank_mask:0xf
    v_and_b32_dpp v18, v43, v6 row_newbcast:0 row_mask:0xf bank_mask:0xf
    v_and_b32_dpp v19, v43, v7 row_newbcast:0 row_mask:0xf bank_mask:0xf
    s_xor_b32 s36, s35, 0xbb000
    s_cbranch_vccnz L_b83
    s_waitcnt vmcnt(4)
L_b83:
    s_waitcnt vmcnt(6)
    buffer_load_dwordx4 v[192:195], v3, s[12:15], s36 offen offset:256 nt
    s_waitcnt lgkmcnt(0)
    v_cmp_eq_u32 vcc, 1, v253
    v_mov_b32 v254, 83
    ds_write_b32 v252, v254 offset:352
    v_mfma_f32_16x16x32_bf16 v[12:15], v[16:19], v[164:167], v[12:15]
    v_and_b32_dpp v20, v43, v4 row_newbcast:4 row_mask:0xf bank_mask:0xf
    v_and_b32_dpp v21, v43, v5 row_newbcast:4 row_mask:0xf bank_mask:0xf
    v_and_b32_dpp v22, v43, v6 row_newbcast:4 row_mask:0xf bank_mask:0xf
    v_and_b32_dpp v23, v43, v7 row_newbcast:4 row_mask:0xf bank_mask:0xf
    s_xor_b32 s36, s35, 0x84000
    s_cbranch_vccnz L_b84
    s_waitcnt vmcnt(4)
L_b84:
    s_waitcnt vmcnt(6)
    buffer_load_dwordx4 v[196:199], v3, s[12:15], s36 offen offset:0 nt
    ds_read_b32 v253, v252 offset:320
    v_mov_b32 v254, 84
    ds_write_b32 v252, v254 offset:352
    v_mfma_f32_16x16x32_bf16 v[12:15], v[20:23], v[168:171], v[12:15]
    v_and_b32_dpp v16, v43, v4 row_newbcast:8 row_mask:0xf bank_mask:0xf
    v_and_b32_dpp v17, v43, v5 row_newbcast:8 row_mask:0xf bank_mask:0xf
    v_and_b32_dpp v18, v43, v6 row_newbcast:8 row_mask:0xf bank_mask:0xf
    v_and_b32_dpp v19, v43, v7 row_newbcast:8 row_mask:0xf bank_mask:0xf
    s_xor_b32 s36, s35, 0x96000
    s_cbranch_vccnz L_b85
    s_waitcnt vmcnt(4)
L_b85:
    s_waitcnt vmcnt(6)
    buffer_load_dwordx4 v[200:203], v3, s[12:15], s36 offen offset:256 nt
    s_waitcnt lgkmcnt(0)
    v_cmp_eq_u32 vcc, 1, v253
    v_mov_b32 v254, 85
    ds_write_b32 v252, v254 offset:352
    v_mfma_f32_16x16x32_bf16 v[12:15], v[16:19], v[172:175], v[12:15]
    v_and_b32_dpp v20, v43, v4 row_newbcast:12 row_mask:0xf bank_mask:0xf
    v_and_b32_dpp v21, v43, v5 row_newbcast:12 row_mask:0xf bank_mask:0xf
    v_and_b32_dpp v22, v43, v6 row_newbcast:12 row_mask:0xf bank_mask:0xf
    v_and_b32_dpp v23, v43, v7 row_newbcast:12 row_mask:0xf bank_mask:0xf
    s_xor_b32 s36, s35, 0x8d000
    s_cbranch_vccnz L_b86
    s_waitcnt vmcnt(4)
L_b86:
    s_waitcnt vmcnt(6)
    buffer_load_dwordx4 v[204:207], v3, s[12:15], s36 offen offset:0 nt
    ds_read_b32 v253, v252 offset:320
    v_mov_b32 v254, 86
    ds_write_b32 v252, v254 offset:352
    v_mfma_f32_16x16x32_bf16 v[12:15], v[20:23], v[176:179], v[12:15]
    v_cvt_pk_bf16_f32 v44, v44, v44
    s_nop 1
    v_and_b32_dpp v16, v44, v4 row_newbcast:0 row_mask:0xf bank_mask:0xf
    v_and_b32_dpp v17, v44, v5 row_newbcast:0 row_mask:0xf bank_mask:0xf
    v_and_b32_dpp v18, v44, v6 row_newbcast:0 row_mask:0xf bank_mask:0xf
    v_and_b32_dpp v19, v44, v7 row_newbcast:0 row_mask:0xf bank_mask:0xf
    s_xor_b32 s36, s35, 0x9f000
    s_cbranch_vccnz L_b87
    s_waitcnt vmcnt(4)
L_b87:
    s_waitcnt vmcnt(6)
    buffer_load_dwordx4 v[208:211], v3, s[12:15], s36 offen offset:256 nt
    s_waitcnt lgkmcnt(0)
    v_cmp_eq_u32 vcc, 1, v253
    v_mov_b32 v254, 87
    ds_write_b32 v252, v254 offset:352
    v_mfma_f32_16x16x32_bf16 v[12:15], v[16:19], v[180:183], v[12:15]
    v_and_b32_dpp v20, v44, v4 row_newbcast:4 row_mask:0xf bank_mask:0xf
    v_and_b32_dpp v21, v44, v5 row_newbcast:4 row_mask:0xf bank_mask:0xf
    v_and_b32_dpp v22, v44, v6 row_newbcast:4 row_mask:0xf bank_mask:0xf
    v_and_b32_dpp v23, v44, v7 row_newbcast:4 row_mask:0xf bank_mask:0xf
    s_xor_b32 s36, s35, 0xe0000
    s_cbranch_vccnz L_b88
    s_waitcnt vmcnt(4)
L_b88:
    s_waitcnt vmcnt(6)
    buffer_load_dwordx4 v[212:215], v3, s[12:15], s36 offen offset:0 nt
    ds_read_b32 v253, v252 offset:320
    v_mov_b32 v254, 88
    ds_write_b32 v252, v254 offset:352
    v_mfma_f32_16x16x32_bf16 v[12:15], v[20:23], v[184:187], v[12:15]
    v_and_b32_dpp v16, v44, v4 row_newbcast:8 row_mask:0xf bank_mask:0xf
    v_and_b32_dpp v17, v44, v5 row_newbcast:8 row_mask:0xf bank_mask:0xf
    v_and_b32_dpp v18, v44, v6 row_newbcast:8 row_mask:0xf bank_mask:0xf
    v_and_b32_dpp v19, v44, v7 row_newbcast:8 row_mask:0xf bank_mask:0xf
    s_xor_b32 s36, s35, 0xf2000
    s_cbranch_vccnz L_b89
    s_waitcnt vmcnt(4)
L_b89:
    s_waitcnt vmcnt(6)
    buffer_load_dwordx4 v[216:219], v3, s[12:15], s36 offen offset:256 nt
    s_waitcnt lgkmcnt(0)
    v_cmp_eq_u32 vcc, 1, v253
    v_mov_b32 v254, 89
    ds_write_b32 v252, v254 offset:352
    v_mfma_f32_16x16x32_bf16 v[12:15], v[16:19], v[188:191], v[12:15]
    v_and_b32_dpp v20, v44, v4 row_newbcast:12 row_mask:0xf bank_mask:0xf
    v_and_b32_dpp v21, v44, v5 row_newbcast:12 row_mask:0xf bank_mask:0xf
    v_and_b32_dpp v22, v44, v6 row_newbcast:12 row_mask:0xf bank_mask:0xf
    v_and_b32_dpp v23, v44, v7 row_newbcast:12 row_mask:0xf bank_mask:0xf
    s_xor_b32 s36, s35, 0xe9000
    s_cbranch_vccnz L_b90
    s_waitcnt vmcnt(4)
L_b90:
    s_waitcnt vmcnt(6)
    buffer_load_dwordx4 v[220:223], v3, s[12:15], s36 offen offset:0 nt
    ds_read_b32 v253, v252 offset:320
    v_mov_b32 v254, 90
    ds_write_b32 v252, v254 offset:352
    v_mfma_f32_16x16x32_bf16 v[12:15], v[20:23], v[192:195], v[12:15]
    v_cvt_pk_bf16_f32 v45, v45, v45
    s_nop 1
    v_and_b32_dpp v16, v45, v4 row_newbcast:0 row_mask:0xf bank_mask:0xf
    v_and_b32_dpp v17, v45, v5 row_newbcast:0 row_mask:0xf bank_mask:0xf
    v_and_b32_dpp v18, v45, v6 row_newbcast:0 row_mask:0xf bank_mask:0xf
    v_and_b32_dpp v19, v45, v7 row_newbcast:0 row_mask:0xf bank_mask:0xf
    s_xor_b32 s36, s35, 0xfb000
    s_cbranch_vccnz L_b91
    s_waitcnt vmcnt(4)
L_b91:
    s_waitcnt vmcnt(6)
    buffer_load_dwordx4 v[224:227], v3, s[12:15], s36 offen offset:256 nt
    s_waitcnt lgkmcnt(0)
    v_cmp_eq_u32 vcc, 1, v253
    v_mov_b32 v254, 91
    ds_write_b32 v252, v254 offset:352
    v_mfma_f32_16x16x32_bf16 v[12:15], v[16:19], v[196:199], v[12:15]
    v_and_b32_dpp v20, v45, v4 row_newbcast:4 row_mask:0xf bank_mask:0xf
    v_and_b32_dpp v21, v45, v5 row_newbcast:4 row_mask:0xf bank_mask:0xf
    v_and_b32_dpp v22, v45, v6 row_newbcast:4 row_mask:0xf bank_mask:0xf
    v_and_b32_dpp v23, v45, v7 row_newbcast:4 row_mask:0xf bank_mask:0xf
    s_xor_b32 s36, s35, 0xc4000
    s_cbranch_vccnz L_b92
    s_waitcnt vmcnt(4)
L_b92:
    s_waitcnt vmcnt(6)
    buffer_load_dwordx4 v[228:231], v3, s[12:15], s36 offen offset:0 nt
    ds_read_b32 v253, v252 offset:320
    v_mov_b32 v254, 92
    ds_write_b32 v252, v254 offset:352
    v_mfma_f32_16x16x32_bf16 v[12:15], v[20:23], v[200:203], v[12:15]
    v_and_b32_dpp v16, v45, v4 row_newbcast:8 row_mask:0xf bank_mask:0xf
    v_and_b32_dpp v17, v45, v5 row_newbcast:8 row_mask:0xf bank_mask:0xf
    v_and_b32_dpp v18, v45, v6 row_newbcast:8 row_mask:0xf bank_mask:0xf
    v_and_b32_dpp v19, v45, v7 row_newbcast:8 row_mask:0xf bank_mask:0xf
    s_xor_b32 s36, s35, 0xd6000
    s_cbranch_vccnz L_b93
    s_waitcnt vmcnt(4)
L_b93:
    s_waitcnt vmcnt(6)
    buffer_load_dwordx4 v[232:235], v3, s[12:15], s36 offen offset:256 nt
    s_waitcnt lgkmcnt(0)
    v_cmp_eq_u32 vcc, 1, v253
    v_mov_b32 v254, 93
    ds_write_b32 v252, v254 offset:352
    v_mfma_f32_16x16x32_bf16 v[12:15], v[16:19], v[204:207], v[12:15]
    v_and_b32_dpp v20, v45, v4 row_newbcast:12 row_mask:0xf bank_mask:0xf
    v_and_b32_dpp v21, v45, v5 row_newbcast:12 row_mask:0xf bank_mask:0xf
    v_and_b32_dpp v22, v45, v6 row_newbcast:12 row_mask:0xf bank_mask:0xf
    v_and_b32_dpp v23, v45, v7 row_newbcast:12 row_mask:0xf bank_mask:0xf
    s_xor_b32 s36, s35, 0xcd000
    s_cbranch_vccnz L_b94
    s_waitcnt vmcnt(4)
L_b94:
    s_waitcnt vmcnt(6)
    buffer_load_dwordx4 v[236:239], v3, s[12:15], s36 offen offset:0 nt
    ds_read_b32 v253, v252 offset:320
    v_mov_b32 v254, 94
    ds_write_b32 v252, v254 offset:352
    v_mfma_f32_16x16x32_bf16 v[12:15], v[20:23], v[208:211], v[12:15]
    v_cvt_pk_bf16_f32 v46, v46, v46
    s_branch L_pg3_skip
L_pg3:
    s_branch L_pg4
L_pg3_skip:
    s_nop 0
    v_and_b32_dpp v16, v46, v4 row_newbcast:0 row_mask:0xf bank_mask:0xf
    v_and_b32_dpp v17, v46, v5 row_newbcast:0 row_mask:0xf bank_mask:0xf
    v_and_b32_dpp v18, v46, v6 row_newbcast:0 row_mask:0xf bank_mask:0xf
    v_and_b32_dpp v19, v46, v7 row_newbcast:0 row_mask:0xf bank_mask:0xf
    s_xor_b32 s36, s35, 0xdf000
    s_cbranch_vccnz L_b95
    s_waitcnt vmcnt(4)
L_b95:
    s_waitcnt vmcnt(6)
    buffer_load_dwordx4 v[240:243], v3, s[12:15], s36 offen offset:256 nt
    s_waitcnt lgkmcnt(0)
    v_cmp_eq_u32 vcc, 1, v253
    v_mov_b32 v254, 95
    ds_write_b32 v252, v254 offset:352
    v_mfma_f32_16x16x32_bf16 v[12:15], v[16:19], v[212:215], v[12:15]
    v_and_b32_dpp v20, v46, v4 row_newbcast:4 row_mask:0xf bank_mask:0xf
    v_and_b32_dpp v21, v46, v5 row_newbcast:4 row_mask:0xf bank_mask:0xf
    v_and_b32_dpp v22, v46, v6 row_newbcast:4 row_mask:0xf bank_mask:0xf
    v_and_b32_dpp v23, v46, v7 row_newbcast:4 row_mask:0xf bank_mask:0xf
    s_xor_b32 s36, s35, 0x4000
    s_cbranch_vccnz L_b96
    s_waitcnt vmcnt(4)
L_b96:
    s_waitcnt vmcnt(6)
    buffer_load_dwordx4 v[244:247], v3, s[12:15], s36 offen offset:0 nt
    ds_read_b32 v253, v252 offset:320
    v_mov_b32 v254, 96
    ds_write_b32 v252, v254 offset:352
    v_mfma_f32_16x16x32_bf16 v[12:15], v[20:23], v[216:219], v[12:15]
    v_and_b32_dpp v16, v46, v4 row_newbcast:8 row_mask:0xf bank_mask:0xf
    v_and_b32_dpp v17, v46, v5 row_newbcast:8 row_mask:0xf bank_mask:0xf
    v_and_b32_dpp v18, v46, v6 row_newbcast:8 row_mask:0xf bank_mask:0xf
    v_and_b32_dpp v19, v46, v7 row_newbcast:8 row_mask:0xf bank_mask:0xf
    s_xor_b32 s36, s35, 0x16000
    s_cbranch_vccnz L_b97
    s_waitcnt vmcnt(4)
L_b97:
    s_waitcnt vmcnt(6)
    buffer_load_dwordx4 v[248:251], v3, s[12:15], s36 offen offset:256 nt
    s_waitcnt lgkmcnt(0)
    v_cmp_eq_u32 vcc, 1, v253
    v_mov_b32 v254, 97
    ds_write_b32 v252, v254 offset:352
    v_mfma_f32_16x16x32_bf16 v[12:15], v[16:19], v[220:223], v[12:15]
    v_and_b32_dpp v20, v46, v4 row_newbcast:12 row_mask:0xf bank_mask:0xf
    v_and_b32_dpp v21, v46, v5 row_newbcast:12 row_mask:0xf bank_mask:0xf
    v_and_b32_dpp v22, v46, v6 row_newbcast:12 row_mask:0xf bank_mask:0xf
    v_and_b32_dpp v23, v46, v7 row_newbcast:12 row_mask:0xf bank_mask:0xf
    s_xor_b32 s36, s35, 0xd000
    s_cbranch_vccnz L_b98
    s_waitcnt vmcnt(4)
L_b98:
    s_waitcnt vmcnt(6)
    buffer_load_dwordx4 v[56:59], v3, s[12:15], s36 offen offset:0 nt
    ds_read_b32 v253, v252 offset:320
    v_mov_b32 v254, 98
    ds_write_b32 v252, v254 offset:352
    v_mfma_f32_16x16x32_bf16 v[12:15], v[20:23], v[224:227], v[12:15]
    v_cvt_pk_bf16_f32 v47, v47, v47
    s_nop 1
    v_and_b32_dpp v16, v47, v4 row_newbcast:0 row_mask:0xf bank_mask:0xf
    v_and_b32_dpp v17, v47, v5 row_newbcast:0 row_mask:0xf bank_mask:0xf
    v_and_b32_dpp v18, v47, v6 row_newbcast:0 row_mask:0xf bank_mask:0xf
    v_and_b32_dpp v19, v47, v7 row_newbcast:0 row_mask:0xf bank_mask:0xf
    s_xor_b32 s36, s35, 0x1f000
    s_cbranch_vccnz L_b99
    s_waitcnt vmcnt(4)
L_b99:
    s_waitcnt vmcnt(6)
    buffer_load_dwordx4 v[60:63], v3, s[12:15], s36 offen offset:256 nt
    s_waitcnt lgkmcnt(0)
    v_cmp_eq_u32 vcc, 1, v253
    v_mov_b32 v254, 99
    ds_write_b32 v252, v254 offset:352
    v_mfma_f32_16x16x32_bf16 v[12:15], v[16:19], v[228:231], v[12:15]
    v_and_b32_dpp v20, v47, v4 row_newbcast:4 row_mask:0xf bank_mask:0xf
    v_and_b32_dpp v21, v47, v5 row_newbcast:4 row_mask:0xf bank_mask:0xf
    v_and_b32_dpp v22, v47, v6 row_newbcast:4 row_mask:0xf bank_mask:0xf
    v_and_b32_dpp v23, v47, v7 row_newbcast:4 row_mask:0xf bank_mask:0xf
    s_xor_b32 s36, s35, 0x20000
    s_cbranch_vccnz L_b100
    s_waitcnt vmcnt(4)
L_b100:
    s_waitcnt vmcnt(6)
    buffer_load_dwordx4 v[64:67], v3, s[12:15], s36 offen offset:0 nt
    ds_read_b32 v253, v252 offset:320
    v_mov_b32 v254, 100
    ds_write_b32 v252, v254 offset:352
    v_mfma_f32_16x16x32_bf16 v[12:15], v[20:23], v[232:235], v[12:15]
    v_and_b32_dpp v16, v47, v4 row_newbcast:8 row_mask:0xf bank_mask:0xf
    v_and_b32_dpp v17, v47, v5 row_newbcast:8 row_mask:0xf bank_mask:0xf
    v_and_b32_dpp v18, v47, v6 row_newbcast:8 row_mask:0xf bank_mask:0xf
    v_and_b32_dpp v19, v47, v7 row_newbcast:8 row_mask:0xf bank_mask:0xf
    s_xor_b32 s36, s35, 0x32000
    s_cbranch_vccnz L_b101
    s_waitcnt vmcnt(4)
L_b101:
    s_waitcnt vmcnt(6)
    buffer_load_dwordx4 v[68:71], v3, s[12:15], s36 offen offset:256 nt
    s_waitcnt lgkmcnt(0)
    v_cmp_eq_u32 vcc, 1, v253
    v_mov_b32 v254, 101
    ds_write_b32 v252, v254 offset:352
    v_mfma_f32_16x16x32_bf16 v[12:15], v[16:19], v[236:239], v[12:15]
    v_and_b32_dpp v20, v47, v4 row_newbcast:12 row_mask:0xf bank_mask:0xf
    v_and_b32_dpp v21, v47, v5 row_newbcast:12 row_mask:0xf bank_mask:0xf
    v_and_b32_dpp v22, v47, v6 row_newbcast:12 row_mask:0xf bank_mask:0xf
    v_and_b32_dpp v23, v47, v7 row_newbcast:12 row_mask:0xf bank_mask:0xf
    s_xor_b32 s36, s35, 0x29000
    s_cbranch_vccnz L_b102
    s_waitcnt vmcnt(4)
L_b102:
    s_waitcnt vmcnt(6)
    buffer_load_dwordx4 v[72:75], v3, s[12:15], s36 offen offset:0 nt
    ds_read_b32 v253, v252 offset:320
    v_mov_b32 v254, 102
    ds_write_b32 v252, v254 offset:352
    v_mfma_f32_16x16x32_bf16 v[12:15], v[20:23], v[240:243], v[12:15]
    v_cvt_pk_bf16_f32 v48, v48, v48
    s_nop 1
    v_and_b32_dpp v16, v48, v4 row_newbcast:0 row_mask:0xf bank_mask:0xf
    v_and_b32_dpp v17, v48, v5 row_newbcast:0 row_mask:0xf bank_mask:0xf
    v_and_b32_dpp v18, v48, v6 row_newbcast:0 row_mask:0xf bank_mask:0xf
    v_and_b32_dpp v19, v48, v7 row_newbcast:0 row_mask:0xf bank_mask:0xf
    s_xor_b32 s36, s35, 0x3b000
    s_cbranch_vccnz L_b103
    s_waitcnt vmcnt(4)
L_b103:
    s_waitcnt vmcnt(6)
    buffer_load_dwordx4 v[76:79], v3, s[12:15], s36 offen offset:256 nt
    s_waitcnt lgkmcnt(0)
    v_cmp_eq_u32 vcc, 1, v253
    v_mov_b32 v254, 103
    ds_write_b32 v252, v254 offset:352
    v_mfma_f32_16x16x32_bf16 v[12:15], v[16:19], v[244:247], v[12:15]
    v_and_b32_dpp v20, v48, v4 row_newbcast:4 row_mask:0xf bank_mask:0xf
    v_and_b32_dpp v21, v48, v5 row_newbcast:4 row_mask:0xf bank_mask:0xf
    v_and_b32_dpp v22, v48, v6 row_newbcast:4 row_mask:0xf bank_mask:0xf
    v_and_b32_dpp v23, v48, v7 row_newbcast:4 row_mask:0xf bank_mask:0xf
    s_xor_b32 s36, s35, 0x44000
    s_cbranch_vccnz L_b104
    s_waitcnt vmcnt(4)
L_b104:
    s_waitcnt vmcnt(6)
    buffer_load_dwordx4 v[80:83], v3, s[12:15], s36 offen offset:0 nt
    ds_read_b32 v253, v252 offset:320
    v_mov_b32 v254, 104
    ds_write_b32 v252, v254 offset:352
    v_mfma_f32_16x16x32_bf16 v[12:15], v[20:23], v[248:251], v[12:15]
    v_and_b32_dpp v16, v48, v4 row_newbcast:8 row_mask:0xf bank_mask:0xf
    v_and_b32_dpp v17, v48, v5 row_newbcast:8 row_mask:0xf bank_mask:0xf
    v_and_b32_dpp v18, v48, v6 row_newbcast:8 row_mask:0xf bank_mask:0xf
    v_and_b32_dpp v19, v48, v7 row_newbcast:8 row_mask:0xf bank_mask:0xf
    s_xor_b32 s36, s35, 0x56000
    s_cbranch_vccnz L_b105
    s_waitcnt vmcnt(4)
L_b105:
    s_waitcnt vmcnt(6)
    buffer_load_dwordx4 v[84:87], v3, s[12:15], s36 offen offset:256 nt
    s_waitcnt lgkmcnt(0)
    v_cmp_eq_u32 vcc, 1, v253
    v_mov_b32 v254, 105
    ds_write_b32 v252, v254 offset:352
    v_mfma_f32_16x16x32_bf16 v[12:15], v[16:19], v[56:59], v[12:15]
    v_and_b32_dpp v20, v48, v4 row_newbcast:12 row_mask:0xf bank_mask:0xf
    v_and_b32_dpp v21, v48, v5 row_newbcast:12 row_mask:0xf bank_mask:0xf
    v_and_b32_dpp v22, v48, v6 row_newbcast:12 row_mask:0xf bank_mask:0xf
    v_and_b32_dpp v23, v48, v7 row_newbcast:12 row_mask:0xf bank_mask:0xf
    s_xor_b32 s36, s35, 0x4d000
    s_cbranch_vccnz L_b106
    s_waitcnt vmcnt(4)
L_b106:
    s_waitcnt vmcnt(6)
    buffer_load_dwordx4 v[88:91], v3, s[12:15], s36 offen offset:0 nt
    ds_read_b32 v253, v252 offset:320
    v_mov_b32 v254, 106
    ds_write_b32 v252, v254 offset:352
    v_mfma_f32_16x16x32_bf16 v[12:15], v[20:23], v[60:63], v[12:15]
    v_cvt_pk_bf16_f32 v49, v49, v49
    s_nop 1
    v_and_b32_dpp v16, v49, v4 row_newbcast:0 row_mask:0xf bank_mask:0xf
    v_and_b32_dpp v17, v49, v5 row_newbcast:0 row_mask:0xf bank_mask:0xf
    v_and_b32_dpp v18, v49, v6 row_newbcast:0 row_mask:0xf bank_mask:0xf
    v_and_b32_dpp v19, v49, v7 row_newbcast:0 row_mask:0xf bank_mask:0xf
    s_xor_b32 s36, s35, 0x5f000
    s_cbranch_vccnz L_b107
    s_waitcnt vmcnt(4)
L_b107:
    s_waitcnt vmcnt(6)
    buffer_load_dwordx4 v[92:95], v3, s[12:15], s36 offen offset:256 nt
    s_waitcnt lgkmcnt(0)
    v_cmp_eq_u32 vcc, 1, v253
    v_mov_b32 v254, 107
    ds_write_b32 v252, v254 offset:352
    v_mfma_f32_16x16x32_bf16 v[12:15], v[16:19], v[64:67], v[12:15]
    v_and_b32_dpp v20, v49, v4 row_newbcast:4 row_mask:0xf bank_mask:0xf
    v_and_b32_dpp v21, v49, v5 row_newbcast:4 row_mask:0xf bank_mask:0xf
    v_and_b32_dpp v22, v49, v6 row_newbcast:4 row_mask:0xf bank_mask:0xf
    v_and_b32_dpp v23, v49, v7 row_newbcast:4 row_mask:0xf bank_mask:0xf
    s_xor_b32 s36, s35, 0x60000
    s_cbranch_vccnz L_b108
    s_waitcnt vmcnt(4)
L_b108:
    s_waitcnt vmcnt(6)
    buffer_load_dwordx4 v[96:99], v3, s[12:15], s36 offen offset:0 nt
    ds_read_b32 v253, v252 offset:320
    v_mov_b32 v254, 108
    ds_write_b32 v252, v254 offset:352
    v_mfma_f32_16x16x32_bf16 v[12:15], v[20:23], v[68:71], v[12:15]
    v_and_b32_dpp v16, v49, v4 row_newbcast:8 row_mask:0xf bank_mask:0xf
    v_and_b32_dpp v17, v49, v5 row_newbcast:8 row_mask:0xf bank_mask:0xf
    v_and_b32_dpp v18, v49, v6 row_newbcast:8 row_mask:0xf bank_mask:0xf
    v_and_b32_dpp v19, v49, v7 row_newbcast:8 row_mask:0xf bank_mask:0xf
    s_xor_b32 s36, s35, 0x72000
    s_cbranch_vccnz L_b109
    s_waitcnt vmcnt(4)
L_b109:
    s_waitcnt vmcnt(6)
    buffer_load_dwordx4 v[100:103], v3, s[12:15], s36 offen offset:256 nt
    s_waitcnt lgkmcnt(0)
    v_cmp_eq_u32 vcc, 1, v253
    v_mov_b32 v254, 109
    ds_write_b32 v252, v254 offset:352
    v_mfma_f32_16x16x32_bf16 v[12:15], v[16:19], v[72:75], v[12:15]
    v_and_b32_dpp v20, v49, v4 row_newbcast:12 row_mask:0xf bank_mask:0xf
    v_and_b32_dpp v21, v49, v5 row_newbcast:12 row_mask:0xf bank_mask:0xf
    v_and_b32_dpp v22, v49, v6 row_newbcast:12 row_mask:0xf bank_mask:0xf
    v_and_b32_dpp v23, v49, v7 row_newbcast:12 row_mask:0xf bank_mask:0xf
    s_xor_b32 s36, s35, 0x69000
    s_cbranch_vccnz L_b110
    s_waitcnt vmcnt(4)
L_b110:
    s_waitcnt vmcnt(6)
    buffer_load_dwordx4 v[104:107], v3, s[12:15], s36 offen offset:0 nt
    ds_read_b32 v253, v252 offset:320
    v_mov_b32 v254, 110
    ds_write_b32 v252, v254 offset:352
    v_mfma_f32_16x16x32_bf16 v[12:15], v[20:23], v[76:79], v[12:15]
    v_cvt_pk_bf16_f32 v50, v50, v50
    s_nop 1
    v_and_b32_dpp v16, v50, v4 row_newbcast:0 row_mask:0xf bank_mask:0xf
    v_and_b32_dpp v17, v50, v5 row_newbcast:0 row_mask:0xf bank_mask:0xf
    v_and_b32_dpp v18, v50, v6 row_newbcast:0 row_mask:0xf bank_mask:0xf
    v_and_b32_dpp v19, v50, v7 row_newbcast:0 row_mask:0xf bank_mask:0xf
    s_xor_b32 s36, s35, 0x7b000
    s_cbranch_vccnz L_b111
    s_waitcnt vmcnt(4)
L_b111:
    s_waitcnt vmcnt(6)
    buffer_load_dwordx4 v[108:111], v3, s[12:15], s36 offen offset:256 nt
    s_waitcnt lgkmcnt(0)
    v_cmp_eq_u32 vcc, 1, v253
    v_mov_b32 v254, 111
    ds_write_b32 v252, v254 offset:352
    v_mfma_f32_16x16x32_bf16 v[12:15], v[16:19], v[80:83], v[12:15]
    v_and_b32_dpp v20, v50, v4 row_newbcast:4 row_mask:0xf bank_mask:0xf
    v_and_b32_dpp v21, v50, v5 row_newbcast:4 row_mask:0xf bank_mask:0xf
    v_and_b32_dpp v22, v50, v6 row_newbcast:4 row_mask:0xf bank_mask:0xf
    v_and_b32_dpp v23, v50, v7 row_newbcast:4 row_mask:0xf bank_mask:0xf
    s_xor_b32 s36, s35, 0xa4000
    s_cbranch_vccnz L_b112
    s_waitcnt vmcnt(4)
L_b112:
    s_waitcnt vmcnt(6)
    buffer_load_dwordx4 v[112:115], v3, s[12:15], s36 offen offset:0 nt
    ds_read_b32 v253, v252 offset:320
    v_mov_b32 v254, 112
    ds_write_b32 v252, v254 offset:352
    v_mfma_f32_16x16x32_bf16 v[12:15], v[20:23], v[84:87], v[12:15]
    v_and_b32_dpp v16, v50, v4 row_newbcast:8 row_mask:0xf bank_mask:0xf
    v_and_b32_dpp v17, v50, v5 row_newbcast:8 row_mask:0xf bank_mask:0xf
    v_and_b32_dpp v18, v50, v6 row_newbcast:8 row_mask:0xf bank_mask:0xf
    v_and_b32_dpp v19, v50, v7 row_newbcast:8 row_mask:0xf bank_mask:0xf
    s_xor_b32 s36, s35, 0xb6000
    s_cbranch_vccnz L_b113
    s_waitcnt vmcnt(4)
L_b113:
    s_waitcnt vmcnt(6)
    buffer_load_dwordx4 v[116:119], v3, s[12:15], s36 offen offset:256 nt
    s_waitcnt lgkmcnt(0)
    v_cmp_eq_u32 vcc, 1, v253
    v_mov_b32 v254, 113
    ds_write_b32 v252, v254 offset:352
    v_mfma_f32_16x16x32_bf16 v[12:15], v[16:19], v[88:91], v[12:15]
    v_and_b32_dpp v20, v50, v4 row_newbcast:12 row_mask:0xf bank_mask:0xf
    v_and_b32_dpp v21, v50, v5 row_newbcast:12 row_mask:0xf bank_mask:0xf
    v_and_b32_dpp v22, v50, v6 row_newbcast:12 row_mask:0xf bank_mask:0xf
    v_and_b32_dpp v23, v50, v7 row_newbcast:12 row_mask:0xf bank_mask:0xf
    s_xor_b32 s36, s35, 0xad000
    s_cbranch_vccnz L_b114
    s_waitcnt vmcnt(4)
L_b114:
    s_waitcnt vmcnt(6)
    buffer_load_dwordx4 v[120:123], v3, s[12:15], s36 offen offset:0 nt
    ds_read_b32 v253, v252 offset:320
    v_mov_b32 v254, 114
    ds_write_b32 v252, v254 offset:352
    v_mfma_f32_16x16x32_bf16 v[12:15], v[20:23], v[92:95], v[12:15]
    v_cvt_pk_bf16_f32 v51, v51, v51
    s_nop 1
    v_and_b32_dpp v16, v51, v4 row_newbcast:0 row_mask:0xf bank_mask:0xf
    v_and_b32_dpp v17, v51, v5 row_newbcast:0 row_mask:0xf bank_mask:0xf
    v_and_b32_dpp v18, v51, v6 row_newbcast:0 row_mask:0xf bank_mask:0xf
    v_and_b32_dpp v19, v51, v7 row_newbcast:0 row_mask:0xf bank_mask:0xf
    s_xor_b32 s36, s35, 0xbf000
    s_cbranch_vccnz L_b115
    s_waitcnt vmcnt(4)
L_b115:
    s_waitcnt vmcnt(6)
    buffer_load_dwordx4 v[124:127], v3, s[12:15], s36 offen offset:256 nt
    s_waitcnt lgkmcnt(0)
    v_cmp_eq_u32 vcc, 1, v253
    v_mov_b32 v254, 115
    ds_write_b32 v252, v254 offset:352
    v_mfma_f32_16x16x32_bf16 v[12:15], v[16:19], v[96:99], v[12:15]
    v_and_b32_dpp v20, v51, v4 row_newbcast:4 row_mask:0xf bank_mask:0xf
    v_and_b32_dpp v21, v51, v5 row_newbcast:4 row_mask:0xf bank_mask:0xf
    v_and_b32_dpp v22, v51, v6 row_newbcast:4 row_mask:0xf bank_mask:0xf
    v_and_b32_dpp v23, v51, v7 row_newbcast:4 row_mask:0xf bank_mask:0xf
    s_xor_b32 s36, s35, 0x80000
    s_cbranch_vccnz L_b116
    s_branch L_pg4_skip
L_pg4:
    s_branch L_pg5
L_pg4_skip:
    s_waitcnt vmcnt(4)
L_b116:
    s_waitcnt vmcnt(6)
    buffer_load_dwordx4 v[128:131], v3, s[12:15], s36 offen offset:0 nt
    ds_read_b32 v253, v252 offset:320
    v_mov_b32 v254, 116
    ds_write_b32 v252, v254 offset:352
    v_mfma_f32_16x16x32_bf16 v[12:15], v[20:23], v[100:103], v[12:15]
    v_and_b32_dpp v16, v51, v4 row_newbcast:8 row_mask:0xf bank_mask:0xf
    v_and_b32_dpp v17, v51, v5 row_newbcast:8 row_mask:0xf bank_mask:0xf
    v_and_b32_dpp v18, v51, v6 row_newbcast:8 row_mask:0xf bank_mask:0xf
    v_and_b32_dpp v19, v51, v7 row_newbcast:8 row_mask:0xf bank_mask:0xf
    s_xor_b32 s36, s35, 0x92000
    s_cbranch_vccnz L_b117
    s_waitcnt vmcnt(4)
L_b117:
    s_waitcnt vmcnt(6)
    buffer_load_dwordx4 v[132:135], v3, s[12:15], s36 offen offset:256 nt
    s_waitcnt lgkmcnt(0)
    v_cmp_eq_u32 vcc, 1, v253
    v_mov_b32 v254, 117
    ds_write_b32 v252, v254 offset:352
    v_mfma_f32_16x16x32_bf16 v[12:15], v[16:19], v[104:107], v[12:15]
    v_and_b32_dpp v20, v51, v4 row_newbcast:12 row_mask:0xf bank_mask:0xf
    v_and_b32_dpp v21, v51, v5 row_newbcast:12 row_mask:0xf bank_mask:0xf
    v_and_b32_dpp v22, v51, v6 row_newbcast:12 row_mask:0xf bank_mask:0xf
    v_and_b32_dpp v23, v51, v7 row_newbcast:12 row_mask:0xf bank_mask:0xf
    s_xor_b32 s36, s35, 0x89000
    s_cbranch_vccnz L_b118
    s_waitcnt vmcnt(4)
L_b118:
    s_waitcnt vmcnt(6)
    buffer_load_dwordx4 v[136:139], v3, s[12:15], s36 offen offset:0 nt
    ds_read_b32 v253, v252 offset:320
    v_mov_b32 v254, 118
    ds_write_b32 v252, v254 offset:352
    v_mfma_f32_16x16x32_bf16 v[12:15], v[20:23], v[108:111], v[12:15]
    v_cvt_pk_bf16_f32 v52, v52, v52
    s_nop 1
    v_and_b32_dpp v16, v52, v4 row_newbcast:0 row_mask:0xf bank_mask:0xf
    v_and_b32_dpp v17, v52, v5 row_newbcast:0 row_mask:0xf bank_mask:0xf
    v_and_b32_dpp v18, v52, v6 row_newbcast:0 row_mask:0xf bank_mask:0xf
    v_and_b32_dpp v19, v52, v7 row_newbcast:0 row_mask:0xf bank_mask:0xf
    s_xor_b32 s36, s35, 0x9b000
    s_cbranch_vccnz L_b119
    s_waitcnt vmcnt(4)
L_b119:
    s_waitcnt vmcnt(6)
    buffer_load_dwordx4 v[140:143], v3, s[12:15], s36 offen offset:256 nt
    s_waitcnt lgkmcnt(0)
    v_cmp_eq_u32 vcc, 1, v253
    v_mov_b32 v254, 119
    ds_write_b32 v252, v254 offset:352
    v_mfma_f32_16x16x32_bf16 v[12:15], v[16:19], v[112:115], v[12:15]
    v_and_b32_dpp v20, v52, v4 row_newbcast:4 row_mask:0xf bank_mask:0xf
    v_and_b32_dpp v21, v52, v5 row_newbcast:4 row_mask:0xf bank_mask:0xf
    v_and_b32_dpp v22, v52, v6 row_newbcast:4 row_mask:0xf bank_mask:0xf
    v_and_b32_dpp v23, v52, v7 row_newbcast:4 row_mask:0xf bank_mask:0xf
    s_xor_b32 s36, s35, 0xe4000
    s_cbranch_vccnz L_b120
    s_waitcnt vmcnt(4)
L_b120:
    s_waitcnt vmcnt(6)
    buffer_load_dwordx4 v[144:147], v3, s[12:15], s36 offen offset:0 nt
    ds_read_b32 v253, v252 offset:320
    v_mov_b32 v254, 120
    ds_write_b32 v252, v254 offset:352
    v_mfma_f32_16x16x32_bf16 v[12:15], v[20:23], v[116:119], v[12:15]
    v_and_b32_dpp v16, v52, v4 row_newbcast:8 row_mask:0xf bank_mask:0xf
    v_and_b32_dpp v17, v52, v5 row_newbcast:8 row_mask:0xf bank_mask:0xf
    v_and_b32_dpp v18, v52, v6 row_newbcast:8 row_mask:0xf bank_mask:0xf
    v_and_b32_dpp v19, v52, v7 row_newbcast:8 row_mask:0xf bank_mask:0xf
    s_xor_b32 s36, s35, 0xf6000
    s_cbranch_vccnz L_b121
    s_waitcnt vmcnt(4)
L_b121:
    s_waitcnt vmcnt(6)
    buffer_load_dwordx4 v[148:151], v3, s[12:15], s36 offen offset:256 nt
    s_waitcnt lgkmcnt(0)
    v_cmp_eq_u32 vcc, 1, v253
    v_mov_b32 v254, 121
    ds_write_b32 v252, v254 offset:352
    v_mfma_f32_16x16x32_bf16 v[12:15], v[16:19], v[120:123], v[12:15]
    v_and_b32_dpp v20, v52, v4 row_newbcast:12 row_mask:0xf bank_mask:0xf
    v_and_b32_dpp v21, v52, v5 row_newbcast:12 row_mask:0xf bank_mask:0xf
    v_and_b32_dpp v22, v52, v6 row_newbcast:12 row_mask:0xf bank_mask:0xf
    v_and_b32_dpp v23, v52, v7 row_newbcast:12 row_mask:0xf bank_mask:0xf
    s_xor_b32 s36, s35, 0xed000
    s_cbranch_vccnz L_b122
    s_waitcnt vmcnt(4)
L_b122:
    s_waitcnt vmcnt(6)
    buffer_load_dwordx4 v[152:155], v3, s[12:15], s36 offen offset:0 nt
    ds_read_b32 v253, v252 offset:320
    v_mov_b32 v254, 122
    ds_write_b32 v252, v254 offset:352
    v_mfma_f32_16x16x32_bf16 v[12:15], v[20:23], v[124:127], v[12:15]
    v_cvt_pk_bf16_f32 v53, v53, v53
    s_nop 1
    v_and_b32_dpp v16, v53, v4 row_newbcast:0 row_mask:0xf bank_mask:0xf
    v_and_b32_dpp v17, v53, v5 row_newbcast:0 row_mask:0xf bank_mask:0xf
    v_and_b32_dpp v18, v53, v6 row_newbcast:0 row_mask:0xf bank_mask:0xf
    v_and_b32_dpp v19, v53, v7 row_newbcast:0 row_mask:0xf bank_mask:0xf
    s_xor_b32 s36, s35, 0xff000
    s_cbranch_vccnz L_b123
    s_waitcnt vmcnt(4)
L_b123:
    s_waitcnt vmcnt(6)
    buffer_load_dwordx4 v[156:159], v3, s[12:15], s36 offen offset:256 nt
    s_waitcnt lgkmcnt(0)
    v_cmp_eq_u32 vcc, 1, v253
    v_mov_b32 v254, 123
    ds_write_b32 v252, v254 offset:352
    v_mfma_f32_16x16x32_bf16 v[12:15], v[16:19], v[128:131], v[12:15]
    v_and_b32_dpp v20, v53, v4 row_newbcast:4 row_mask:0xf bank_mask:0xf
    v_and_b32_dpp v21, v53, v5 row_newbcast:4 row_mask:0xf bank_mask:0xf
    v_and_b32_dpp v22, v53, v6 row_newbcast:4 row_mask:0xf bank_mask:0xf
    v_and_b32_dpp v23, v53, v7 row_newbcast:4 row_mask:0xf bank_mask:0xf
    s_xor_b32 s36, s35, 0xc0000
    s_cbranch_vccnz L_b124
    s_waitcnt vmcnt(4)
L_b124:
    s_waitcnt vmcnt(6)
    buffer_load_dwordx4 v[160:163], v3, s[12:15], s36 offen offset:0 nt
    ds_read_b32 v253, v252 offset:320
    v_mfma_f32_16x16x32_bf16 v[12:15], v[20:23], v[132:135], v[12:15]
    v_and_b32_dpp v16, v53, v4 row_newbcast:8 row_mask:0xf bank_mask:0xf
    v_and_b32_dpp v17, v53, v5 row_newbcast:8 row_mask:0xf bank_mask:0xf
    v_and_b32_dpp v18, v53, v6 row_newbcast:8 row_mask:0xf bank_mask:0xf
    v_and_b32_dpp v19, v53, v7 row_newbcast:8 row_mask:0xf bank_mask:0xf
    s_xor_b32 s36, s35, 0xd2000
    s_cbranch_vccnz L_b125
    s_waitcnt vmcnt(4)
L_b125:
    s_waitcnt vmcnt(6)
    buffer_load_dwordx4 v[164:167], v3, s[12:15], s36 offen offset:256 nt
    s_waitcnt lgkmcnt(0)
    v_cmp_eq_u32 vcc, 1, v253
    v_mfma_f32_16x16x32_bf16 v[12:15], v[16:19], v[136:139], v[12:15]
    v_and_b32_dpp v20, v53, v4 row_newbcast:12 row_mask:0xf bank_mask:0xf
    v_and_b32_dpp v21, v53, v5 row_newbcast:12 row_mask:0xf bank_mask:0xf
    v_and_b32_dpp v22, v53, v6 row_newbcast:12 row_mask:0xf bank_mask:0xf
    v_and_b32_dpp v23, v53, v7 row_newbcast:12 row_mask:0xf bank_mask:0xf
    s_xor_b32 s36, s35, 0xc9000
    s_cbranch_vccnz L_b126
    s_waitcnt vmcnt(4)
L_b126:
    s_waitcnt vmcnt(6)
    buffer_load_dwordx4 v[168:171], v3, s[12:15], s36 offen offset:0 nt
    v_mfma_f32_16x16x32_bf16 v[12:15], v[20:23], v[140:143], v[12:15]
    v_cvt_pk_bf16_f32 v54, v54, v54
    s_nop 1
    v_and_b32_dpp v16, v54, v4 row_newbcast:0 row_mask:0xf bank_mask:0xf
    v_and_b32_dpp v17, v54, v5 row_newbcast:0 row_mask:0xf bank_mask:0xf
    v_and_b32_dpp v18, v54, v6 row_newbcast:0 row_mask:0xf bank_mask:0xf
    v_and_b32_dpp v19, v54, v7 row_newbcast:0 row_mask:0xf bank_mask:0xf
    s_xor_b32 s36, s35, 0xdb000
    s_cbranch_vccnz L_b127
    s_waitcnt vmcnt(4)
L_b127:
    s_waitcnt vmcnt(6)
    buffer_load_dwordx4 v[172:175], v3, s[12:15], s36 offen offset:256 nt
    v_mfma_f32_16x16x32_bf16 v[12:15], v[16:19], v[144:147], v[12:15]
    v_and_b32_dpp v20, v54, v4 row_newbcast:4 row_mask:0xf bank_mask:0xf
    v_and_b32_dpp v21, v54, v5 row_newbcast:4 row_mask:0xf bank_mask:0xf
    v_and_b32_dpp v22, v54, v6 row_newbcast:4 row_mask:0xf bank_mask:0xf
    v_and_b32_dpp v23, v54, v7 row_newbcast:4 row_mask:0xf bank_mask:0xf
    s_waitcnt vmcnt(6)
    s_nop 0
    v_mfma_f32_16x16x32_bf16 v[12:15], v[20:23], v[148:151], v[12:15]
    v_and_b32_dpp v16, v54, v4 row_newbcast:8 row_mask:0xf bank_mask:0xf
    v_and_b32_dpp v17, v54, v5 row_newbcast:8 row_mask:0xf bank_mask:0xf
    v_and_b32_dpp v18, v54, v6 row_newbcast:8 row_mask:0xf bank_mask:0xf
    v_and_b32_dpp v19, v54, v7 row_newbcast:8 row_mask:0xf bank_mask:0xf
    s_waitcnt vmcnt(5)
    s_nop 0
    v_mfma_f32_16x16x32_bf16 v[12:15], v[16:19], v[152:155], v[12:15]
    v_and_b32_dpp v20, v54, v4 row_newbcast:12 row_mask:0xf bank_mask:0xf
    v_and_b32_dpp v21, v54, v5 row_newbcast:12 row_mask:0xf bank_mask:0xf
    v_and_b32_dpp v22, v54, v6 row_newbcast:12 row_mask:0xf bank_mask:0xf
    v_and_b32_dpp v23, v54, v7 row_newbcast:12 row_mask:0xf bank_mask:0xf
    s_waitcnt vmcnt(4)
    s_nop 0
    v_mfma_f32_16x16x32_bf16 v[12:15], v[20:23], v[156:159], v[12:15]
    v_cvt_pk_bf16_f32 v55, v55, v55
    s_nop 1
    v_and_b32_dpp v16, v55, v4 row_newbcast:0 row_mask:0xf bank_mask:0xf
    v_and_b32_dpp v17, v55, v5 row_newbcast:0 row_mask:0xf bank_mask:0xf
    v_and_b32_dpp v18, v55, v6 row_newbcast:0 row_mask:0xf bank_mask:0xf
    v_and_b32_dpp v19, v55, v7 row_newbcast:0 row_mask:0xf bank_mask:0xf
    s_add_u32 m0, s43, 0
    s_waitcnt vmcnt(3)
    buffer_load_dwordx4 v24, s[20:23], s44 offen nt lds
    v_mfma_f32_16x16x32_bf16 v[12:15], v[16:19], v[160:163], v[12:15]
    v_and_b32_dpp v20, v55, v4 row_newbcast:4 row_mask:0xf bank_mask:0xf
    v_and_b32_dpp v21, v55, v5 row_newbcast:4 row_mask:0xf bank_mask:0xf
    v_and_b32_dpp v22, v55, v6 row_newbcast:4 row_mask:0xf bank_mask:0xf
    v_and_b32_dpp v23, v55, v7 row_newbcast:4 row_mask:0xf bank_mask:0xf
    s_add_u32 m0, s43, 4096
    s_add_u32 s44, s44, 40960
    buffer_load_dwordx4 v24, s[20:23], s44 offen nt lds
    s_add_u32 m0, s43, 8192
    s_add_u32 s44, s44, 40960
    buffer_load_dwordx4 v24, s[20:23], s44 offen nt lds
    s_add_u32 m0, s43, 12288
    s_add_u32 s44, s44, 40960
    buffer_load_dwordx4 v24, s[20:23], s44 offen nt lds
    s_waitcnt vmcnt(6)
    v_mfma_f32_16x16x32_bf16 v[12:15], v[20:23], v[164:167], v[12:15]
    v_and_b32_dpp v16, v55, v4 row_newbcast:8 row_mask:0xf bank_mask:0xf
    v_and_b32_dpp v17, v55, v5 row_newbcast:8 row_mask:0xf bank_mask:0xf
    v_and_b32_dpp v18, v55, v6 row_newbcast:8 row_mask:0xf bank_mask:0xf
    v_and_b32_dpp v19, v55, v7 row_newbcast:8 row_mask:0xf bank_mask:0xf
    s_waitcnt vmcnt(5)
    s_nop 0
    v_mfma_f32_16x16x32_bf16 v[12:15], v[16:19], v[168:171], v[12:15]
    v_and_b32_dpp v20, v55, v4 row_newbcast:12 row_mask:0xf bank_mask:0xf
    v_and_b32_dpp v21, v55, v5 row_newbcast:12 row_mask:0xf bank_mask:0xf
    v_and_b32_dpp v22, v55, v6 row_newbcast:12 row_mask:0xf bank_mask:0xf
    v_and_b32_dpp v23, v55, v7 row_newbcast:12 row_mask:0xf bank_mask:0xf
    s_waitcnt vmcnt(4)
    s_nop 0
    v_mfma_f32_16x16x32_bf16 v[12:15], v[20:23], v[172:175], v[12:15]
    s_mov_b32 exec_hi, 0
    s_nop 6
    ds_write_b128 v9, v[12:15] offset:512
    s_mov_b32 exec_hi, -1
    s_waitcnt lgkmcnt(0)
    s_barrier
    s_barrier
    buffer_load_dwordx4 v[56:59], v31, s[28:31], s48 offen sc1
    buffer_load_dwordx4 v[60:63], v31, s[28:31], s48 offen offset:1024 sc1
    s_waitcnt vmcnt(2)
    s_barrier
    ds_read_b64_tr_b16 v[40:41], v30 offset:4096
    ds_read_b64_tr_b16 v[42:43], v30 offset:4608
    ds_read_b64_tr_b16 v[48:49], v30 offset:5120
    ds_read_b64_tr_b16 v[50:51], v30 offset:5632
    ds_read_b64_tr_b16 v[44:45], v30 offset:12288
    ds_read_b64_tr_b16 v[46:47], v30 offset:12800
    ds_read_b64_tr_b16 v[52:53], v30 offset:13312
    ds_read_b64_tr_b16 v[54:55], v30 offset:13824
L_tile:
    s_waitcnt vmcnt(0)
    v_max3_u32 v12, v56, v57, v58
    v_max3_u32 v13, v59, v60, v61
    v_max3_u32 v12, v12, v62, v63
    v_max_u32 v12, v12, v13
    v_cmp_eq_u32 vcc, -1, v12
    s_nop 0
    s_cbranch_vccz L_mul
L_pollo:
    s_mov_b64 exec, vcc
    buffer_load_dwordx4 v[56:59], v31, s[28:31], s48 offen sc1
    buffer_load_dwordx4 v[60:63], v31, s[28:31], s48 offen offset:1024 sc1
    s_mov_b64 exec, -1
    s_add_u32 s41, s41, 1
    s_cmp_ge_u32 s41, 0x100000
    s_cbranch_scc1 L_fin
L_mul:
    s_waitcnt vmcnt(1) lgkmcnt(4)
    v_mfma_f32_16x16x32_bf16 v[16:19], v[56:59], v[40:43], 0
    v_mfma_f32_16x16x32_bf16 v[20:23], v[56:59], v[48:51], 0
    v_max3_u32 v12, v56, v57, v58
    s_waitcnt vmcnt(0) lgkmcnt(0)
    v_mfma_f32_16x16x32_bf16 v[16:19], v[60:63], v[44:47], v[16:19]
    v_max3_u32 v13, v59, v60, v61
    v_max3_u32 v12, v12, v62, v63
    v_mfma_f32_16x16x32_bf16 v[20:23], v[60:63], v[52:55], v[20:23]
    v_max_u32 v12, v12, v13
    v_cmp_eq_u32 vcc, -1, v12
    s_nop 0
    s_cbranch_vccnz L_pollo
    s_nop 0
    v_add_f32 v16, v16, v18
    s_nop 1
    v_add_f32 v17, v21, v23
    v_add_f32 v18, v16, v17
    v_add_f32 v16, v16, v17
    s_nop 1
    v_permlane32_swap_b32 v16, v18
    s_mov_b64 exec, s[50:51]
    v_add_f32 v34, v16, v18
    s_mov_b64 exec, s[52:53]
    buffer_atomic_add_f32 v34, v32, s[28:31], s47 offen sc0
    v_add_f32 v16, v16, v18
    s_waitcnt vmcnt(0)
    v_cmp_eq_f32 vcc, s49, v34
    v_add_f32 v16, v16, v34
    s_and_b32 s37, vcc_lo, 0x01000100
    s_and_b32 s38, vcc_hi, 0x00010001
    v_cvt_pk_bf16_f32 v16, v16, v16
    s_lshr_b32 s39, s37, 8
    s_sub_u32 exec_lo, s37, s39
    s_mul_i32 exec_hi, s38, 0xff00
    s_cbranch_execz L_fin
    buffer_store_short v16, v33, s[24:27], s3 offen
    s_cmp_lg_u32 s3, 0
    s_cbranch_scc1 L_fin
    s_and_b64 exec, exec, 1
    s_cbranch_scc0 L_fin
    s_add_u32 s42, s42, 1
    s_mov_b32 s37, 0xd0000
    v_mov_b32 v12, s42
    buffer_store_dword v12, off, s[28:31], s37
L_fin:
    s_endpgm
L_pg5:
    s_endpgm
L_service:
    s_mov_b32 s30, 0x40000000
    s_mov_b32 s31, 0x20000
    s_mov_b32 s26, 0xa00
    s_mov_b32 s27, 0x20000
    s_waitcnt lgkmcnt(0)
    s_cmp_eq_u32 s32, 6
    s_cbranch_scc1 L_fin
    s_load_dword s42, s[28:29], 0xd0000
    s_mov_b32 s41, 0
    s_cmp_eq_u32 s32, 7
    s_cbranch_scc1 L_ctrl
    s_add_u32 s46, s34, 32
    v_lshrrev_b32 v10, 4, v1
    v_and_b32 v11, 15, v1
    v_lshlrev_b32 v32, 8, v10
    v_lshl_add_u32 v32, v11, 2, v32
    v_and_b32 v33, 1, v10
    v_mul_u32_u24 v33, 1280, v33
    v_lshl_add_u32 v33, v11, 1, v33
    v_lshlrev_b32 v31, 4, v1
    v_mov_b32 v34, 1.0
    s_lshl_b32 s3, s46, 5
    s_lshl_b32 s47, s46, 10
    s_add_u32 s47, s47, 0x80000
    s_lshl_b32 s48, s33, 12
    s_mov_b32 s49, 0x41f80000
    s_mov_b32 s50, 0x00ff00ff
    s_mov_b32 s51, 0xff00ff00
    s_mov_b32 s52, 0x01ff01ff
    s_mov_b32 s53, 0xff01ff01
    s_lshl_b32 s43, s34, 8
    s_add_u32 s43, s43, 0xcc000
    s_waitcnt lgkmcnt(0)
    s_add_u32 s45, s42, 1
    s_cmp_lg_u32 s33, s34
    s_cbranch_scc1 L_noclear
    v_lshrrev_b32 v2, 3, v1
    v_lshlrev_b32 v2, 8, v2
    v_and_b32 v3, 7, v1
    v_lshl_add_u32 v2, v3, 4, v2
    v_mov_b32 v4, 0
    v_mov_b32 v5, 0
    v_mov_b32 v6, 0
    v_mov_b32 v7, 0
    s_lshl_b32 s44, s34, 12
    s_add_u32 s44, s44, 0x80000
    buffer_store_dwordx4 v[4:7], v2, s[28:31], s44 offen sc1
    buffer_store_dwordx4 v[4:7], v2, s[28:31], s44 offen offset:2048 sc1
    s_mov_b32 exec_hi, 0
    buffer_store_dwordx4 v[4:7], v2, s[28:31], s47 offen sc1
    s_lshl_b32 s44, s34, 9
    s_cmp_ge_u32 s34, 5
    s_cbranch_scc1 L_nozero
    buffer_store_dwordx4 v[4:7], v31, s[24:27], s44 offen sc1
L_nozero:
    v_lshlrev_b32 v3, 2, v1
    v_mov_b32 v8, s45
    s_waitcnt vmcnt(0)
    buffer_store_dword v8, v3, s[28:31], s43 offen sc1
    s_mov_b32 exec_hi, -1
L_noclear:
    s_mov_b32 s22, 0x500000
    s_mov_b32 s23, 0x20000
    s_mul_i32 s44, s33, 163840
    s_add_u32 s44, s44, s3
    v_lshrrev_b32 v2, 1, v1
    v_mul_u32_u24 v2, 1280, v2
    v_and_b32 v3, 1, v1
    v_lshl_add_u32 v2, v3, 4, v2
    v_and_b32 v3, 15, v1
    v_lshlrev_b32 v30, 9, v12
    v_lshl_add_u32 v30, v3, 3, v30
    s_mov_b32 m0, 20480
    s_nop 0
    buffer_load_dwordx4 v2, s[20:23], s44 offen nt lds
    s_mov_b32 m0, 21504
    s_add_u32 s44, s44, 40960
    buffer_load_dwordx4 v2, s[20:23], s44 offen nt lds
    s_mov_b32 m0, 22528
    s_add_u32 s44, s44, 40960
    buffer_load_dwordx4 v2, s[20:23], s44 offen nt lds
    s_mov_b32 m0, 23552
    s_add_u32 s44, s44, 40960
    buffer_load_dwordx4 v2, s[20:23], s44 offen nt lds
    s_barrier
    s_mov_b64 exec, 1
L_flag:
    buffer_load_dword v8, off, s[28:31], s43 sc1
    s_add_u32 s41, s41, 1
    s_cmp_ge_u32 s41, 0x100000
    s_cbranch_scc1 L_flagged
    s_waitcnt vmcnt(0)
    v_cmp_ne_u32 vcc, s45, v8
    s_nop 0
    s_cbranch_vccnz L_flag
L_flagged:
    s_mov_b64 exec, -1
    s_waitcnt vmcnt(0)
    ds_read_b64_tr_b16 v[40:41], v30 offset:20480
    ds_read_b64_tr_b16 v[42:43], v30 offset:20608
    ds_read_b64_tr_b16 v[48:49], v30 offset:20736
    ds_read_b64_tr_b16 v[50:51], v30 offset:20864
    ds_read_b64_tr_b16 v[44:45], v30 offset:22528
    ds_read_b64_tr_b16 v[46:47], v30 offset:22656
    ds_read_b64_tr_b16 v[52:53], v30 offset:22784
    ds_read_b64_tr_b16 v[54:55], v30 offset:22912
    s_barrier
    s_barrier
    buffer_load_dwordx4 v[56:59], v31, s[28:31], s48 offen sc1
    buffer_load_dwordx4 v[60:63], v31, s[28:31], s48 offen offset:1024 sc1
    s_barrier
    s_branch L_tile
L_ctrl:
    s_and_b32 s43, s2, 7
    s_lshl_b32 s43, s43, 8
    s_add_u32 s43, s43, 0xc8000
    s_lshr_b32 s44, s2, 3
    s_lshl_b32 s44, s44, 2
    s_add_u32 s44, s44, s43
    v_lshlrev_b32 v10, 2, v1
    v_mov_b32 v9, 0
    v_and_b32 v8, 12, v10
    ds_write_b32 v8, v9 offset:352
    s_mov_b32 s45, 38
    s_mov_b32 exec_hi, 0
    s_mov_b32 s50, 0xffff
    s_mov_b32 s53, -192
    s_waitcnt lgkmcnt(0)
    s_add_u32 s51, s42, 1
    s_and_b32 s51, s51, s50
L_ctl:
    ds_read_b32 v11, v9 offset:352
    s_add_u32 s41, s41, 1
    s_cmp_ge_u32 s41, 0x100000
    s_cbranch_scc1 L_fin
    s_waitcnt lgkmcnt(0)
    v_readfirstlane_b32 s37, v11
    v_lshl_or_b32 v12, v11, 16, s51
    s_cmp_ge_u32 s37, s45
    s_cbranch_scc1 L_ctlev
    s_mov_b32 exec_lo, 1
    buffer_store_dword v12, off, s[28:31], s44
    s_mov_b32 exec_lo, -1
    buffer_load_dword v13, v10, s[28:31], s43 offen sc1
    s_waitcnt vmcnt(0)
    ds_read_b32 v15, v8 offset:352
    v_and_b32 v14, s50, v13
    v_cmp_eq_u32 vcc, s51, v14
    v_lshrrev_b32 v13, 16, v13
    s_nop 0
    v_cndmask_b32 v13, v11, v13, vcc
    s_nop 1
    v_add_u32_dpp v13, v13, v13 quad_perm:[1,0,3,2] row_mask:0xf bank_mask:0xf
    s_nop 1
    v_add_u32_dpp v13, v13, v13 quad_perm:[2,3,0,1] row_mask:0xf bank_mask:0xf
    s_nop 1
    v_add_u32_dpp v13, v13, v13 row_ror:4 row_mask:0xf bank_mask:0xf
    s_nop 1
    v_add_u32_dpp v13, v13, v13 row_ror:8 row_mask:0xf bank_mask:0xf
    s_nop 0
    v_readlane_b32 s38, v13, 0
    v_readlane_b32 s39, v13, 16
    s_nop 0
    s_add_u32 s38, s38, s39
    s_waitcnt lgkmcnt(0)
    v_lshl_add_u32 v15, v15, 5, s53
    v_cmp_gt_i32 vcc, s38, v15
    s_nop 1
    v_cndmask_b32 v14, 0, 1, vcc
    s_mov_b32 exec_lo, 15
    ds_write_b32 v10, v14 offset:320
    s_mov_b32 exec_lo, -1
    s_branch L_ctl
L_ctlev:
    s_cmp_eq_u32 s45, 122
    s_cbranch_scc1 L_ctlend
    s_mov_b32 s45, 122
    s_barrier
    s_branch L_ctl
L_ctlend:
    s_or_b32 s37, s51, 0x800000
    v_mov_b32 v12, s37
    s_mov_b32 exec_lo, 1
    buffer_store_dword v12, off, s[28:31], s44
    s_barrier
    s_barrier
    s_barrier
    s_endpgm
L_lead:
    s_mov_b32 s30, 0x40000000
    s_mov_b32 s31, 0x20000
    s_load_dword s42, s[28:29], 0xd0000
    s_mov_b32 s41, 0
    s_movk_i32 s50, 0xff
    s_lshr_b32 s46, s34, 2
    s_lshl_b32 s39, s33, 3
    s_add_u32 s39, s39, s34
    s_lshl_b32 s54, s39, 7
    s_add_u32 s54, s54, 0xc0000
    v_lshlrev_b32 v4, 2, v1
    v_mov_b32 v16, -1
    s_mov_b64 exec, 0xff
    ds_write_b32 v4, v16 offset:256
    s_mov_b64 exec, -1
    v_bfe_u32 v15, v1, 1, 2
    v_and_b32 v14, 1, v1
    v_cmp_eq_u32 vcc, 1, v14
    v_mov_b32 v5, 0x0c0c0100
    v_mov_b32 v6, 0x01000c0c
    v_cndmask_b32 v5, v5, v6, vcc
    v_mov_b32 v6, 0x0c0c0302
    v_mov_b32 v7, 0x03020c0c
    v_cndmask_b32 v6, v6, v7, vcc
    v_mov_b32 v7, 0x0c0c0c0c
    s_lshl_b32 s45, s33, 12
    s_and_b32 s37, s34, 2
    s_lshl_b32 s37, s37, 6
    s_add_u32 s45, s45, s37
    s_lshl_b32 s37, s46, 6
    s_add_u32 s45, s45, s37
    s_and_b32 s37, s34, 1
    s_lshl_b32 s37, s37, 5
    s_add_u32 s45, s45, s37
    v_lshrrev_b32 v4, 3, v1
    v_lshlrev_b32 v4, 8, v4
    v_and_b32 v14, 7, v1
    v_lshl_add_u32 v4, v14, 2, v4
    v_cmp_eq_u32 vcc, 0, v15
    s_nop 1
    v_cndmask_b32 v32, v7, v5, vcc
    v_cndmask_b32 v36, v7, v6, vcc
    v_cmp_eq_u32 vcc, 1, v15
    s_nop 1
    v_cndmask_b32 v33, v7, v5, vcc
    v_cndmask_b32 v37, v7, v6, vcc
    v_cmp_eq_u32 vcc, 2, v15
    s_nop 1
    v_cndmask_b32 v34, v7, v5, vcc
    v_cndmask_b32 v38, v7, v6, vcc
    v_cmp_eq_u32 vcc, 3, v15
    s_nop 1
    v_cndmask_b32 v35, v7, v5, vcc
    v_cndmask_b32 v39, v7, v6, vcc
    s_lshl_b32 s43, s33, 13
    s_add_u32 s43, s43, 0x40000
    s_lshl_b32 s37, s46, 12
    s_add_u32 s44, s43, s37
    s_lshl_b32 s37, s34, 9
    s_add_u32 s43, s43, s37
    v_lshrrev_b32 v5, 5, v1
    v_lshlrev_b32 v5, 12, v5
    v_and_b32 v6, 31, v1
    v_lshl_add_u32 v5, v6, 4, v5
    v_lshlrev_b32 v6, 4, v1
    s_waitcnt lgkmcnt(0)
    s_add_u32 s51, s42, 1
    s_and_b32 s51, s51, 0xffff
    s_getreg_b32 s37, hwreg(HW_REG_XCC_ID, 0, 3)
    s_lshl_b32 s37, s37, 4
    s_and_b32 s53, s51, 15
    s_or_b32 s53, s53, s37
    v_mov_b32 v7, s53
    s_waitcnt vmcnt(20)
    v_perm_b32 v40, v20, v20, v32
    v_perm_b32 v41, v20, v20, v33
    v_perm_b32 v42, v20, v20, v34
    v_perm_b32 v43, v20, v20, v35
    s_waitcnt vmcnt(19)
    s_nop 0
    v_mfma_f32_16x16x32_bf16 v[8:11], v[40:43], v[48:51], 0
    v_perm_b32 v44, v20, v20, v36
    v_perm_b32 v45, v20, v20, v37
    v_perm_b32 v46, v20, v20, v38
    v_perm_b32 v47, v20, v20, v39
    s_waitcnt vmcnt(18)
    s_nop 0
    v_mfma_f32_16x16x32_bf16 v[8:11], v[44:47], v[52:55], v[8:11]
    v_perm_b32 v40, v21, v21, v32
    v_perm_b32 v41, v21, v21, v33
    v_perm_b32 v42, v21, v21, v34
    v_perm_b32 v43, v21, v21, v35
    s_waitcnt vmcnt(17)
    s_nop 0
    v_mfma_f32_16x16x32_bf16 v[8:11], v[40:43], v[56:59], v[8:11]
    v_perm_b32 v44, v21, v21, v36
    v_perm_b32 v45, v21, v21, v37
    v_perm_b32 v46, v21, v21, v38
    v_perm_b32 v47, v21, v21, v39
    s_waitcnt vmcnt(16)
    s_nop 0
    v_mfma_f32_16x16x32_bf16 v[8:11], v[44:47], v[60:63], v[8:11]
    v_perm_b32 v40, v22, v22, v32
    v_perm_b32 v41, v22, v22, v33
    v_perm_b32 v42, v22, v22, v34
    v_perm_b32 v43, v22, v22, v35
    s_waitcnt vmcnt(15)
    s_nop 0
    v_mfma_f32_16x16x32_bf16 v[8:11], v[40:43], v[64:67], v[8:11]
    v_perm_b32 v44, v22, v22, v36
    v_perm_b32 v45, v22, v22, v37
    v_perm_b32 v46, v22, v22, v38
    v_perm_b32 v47, v22, v22, v39
    s_waitcnt vmcnt(14)
    s_nop 0
    v_mfma_f32_16x16x32_bf16 v[8:11], v[44:47], v[68:71], v[8:11]
    v_perm_b32 v40, v23, v23, v32
    v_perm_b32 v41, v23, v23, v33
    v_perm_b32 v42, v23, v23, v34
    v_perm_b32 v43, v23, v23, v35
    s_waitcnt vmcnt(13)
    s_nop 0
    v_mfma_f32_16x16x32_bf16 v[8:11], v[40:43], v[72:75], v[8:11]
    v_perm_b32 v44, v23, v23, v36
    v_perm_b32 v45, v23, v23, v37
    v_perm_b32 v46, v23, v23, v38
    v_perm_b32 v47, v23, v23, v39
    s_waitcnt vmcnt(12)
    s_nop 0
    v_mfma_f32_16x16x32_bf16 v[8:11], v[44:47], v[76:79], v[8:11]
    v_perm_b32 v40, v24, v24, v32
    v_perm_b32 v41, v24, v24, v33
    v_perm_b32 v42, v24, v24, v34
    v_perm_b32 v43, v24, v24, v35
    s_waitcnt vmcnt(11)
    s_nop 0
    v_mfma_f32_16x16x32_bf16 v[8:11], v[40:43], v[80:83], v[8:11]
    v_perm_b32 v44, v24, v24, v36
    v_perm_b32 v45, v24, v24, v37
    v_perm_b32 v46, v24, v24, v38
    v_perm_b32 v47, v24, v24, v39
    s_waitcnt vmcnt(10)
    s_nop 0
    v_mfma_f32_16x16x32_bf16 v[8:11], v[44:47], v[84:87], v[8:11]
    v_perm_b32 v40, v25, v25, v32
    v_perm_b32 v41, v25, v25, v33
    v_perm_b32 v42, v25, v25, v34
    v_perm_b32 v43, v25, v25, v35
    s_waitcnt vmcnt(9)
    s_nop 0
    v_mfma_f32_16x16x32_bf16 v[8:11], v[40:43], v[88:91], v[8:11]
    v_perm_b32 v44, v25, v25, v36
    v_perm_b32 v45, v25, v25, v37
    v_perm_b32 v46, v25, v25, v38
    v_perm_b32 v47, v25, v25, v39
    s_waitcnt vmcnt(8)
    s_nop 0
    v_mfma_f32_16x16x32_bf16 v[8:11], v[44:47], v[92:95], v[8:11]
    v_perm_b32 v40, v26, v26, v32
    v_perm_b32 v41, v26, v26, v33
    v_perm_b32 v42, v26, v26, v34
    v_perm_b32 v43, v26, v26, v35
    s_waitcnt vmcnt(7)
    s_nop 0
    v_mfma_f32_16x16x32_bf16 v[8:11], v[40:43], v[96:99], v[8:11]
    v_perm_b32 v44, v26, v26, v36
    v_perm_b32 v45, v26, v26, v37
    v_perm_b32 v46, v26, v26, v38
    v_perm_b32 v47, v26, v26, v39
    s_waitcnt vmcnt(6)
    s_nop 0
    v_mfma_f32_16x16x32_bf16 v[8:11], v[44:47], v[100:103], v[8:11]
    v_perm_b32 v40, v27, v27, v32
    v_perm_b32 v41, v27, v27, v33
    v_perm_b32 v42, v27, v27, v34
    v_perm_b32 v43, v27, v27, v35
    s_waitcnt vmcnt(5)
    s_nop 0
    v_mfma_f32_16x16x32_bf16 v[8:11], v[40:43], v[104:107], v[8:11]
    v_perm_b32 v44, v27, v27, v36
    v_perm_b32 v45, v27, v27, v37
    v_perm_b32 v46, v27, v27, v38
    v_perm_b32 v47, v27, v27, v39
    s_waitcnt vmcnt(4)
    s_nop 0
    v_mfma_f32_16x16x32_bf16 v[8:11], v[44:47], v[108:111], v[8:11]
    v_perm_b32 v40, v28, v28, v32
    v_perm_b32 v41, v28, v28, v33
    v_perm_b32 v42, v28, v28, v34
    v_perm_b32 v43, v28, v28, v35
    s_waitcnt vmcnt(3)
    s_nop 0
    v_mfma_f32_16x16x32_bf16 v[8:11], v[40:43], v[112:115], v[8:11]
    v_perm_b32 v44, v28, v28, v36
    v_perm_b32 v45, v28, v28, v37
    v_perm_b32 v46, v28, v28, v38
    v_perm_b32 v47, v28, v28, v39
    s_waitcnt vmcnt(2)
    s_nop 0
    v_mfma_f32_16x16x32_bf16 v[8:11], v[44:47], v[116:119], v[8:11]
    v_perm_b32 v40, v29, v29, v32
    v_perm_b32 v41, v29, v29, v33
    v_perm_b32 v42, v29, v29, v34
    v_perm_b32 v43, v29, v29, v35
    s_waitcnt vmcnt(1)
    s_nop 0
    v_mfma_f32_16x16x32_bf16 v[8:11], v[40:43], v[120:123], v[8:11]
    v_perm_b32 v44, v29, v29, v36
    v_perm_b32 v45, v29, v29, v37
    v_perm_b32 v46, v29, v29, v38
    v_perm_b32 v47, v29, v29, v39
    s_waitcnt vmcnt(0)
    s_nop 0
    v_mfma_f32_16x16x32_bf16 v[8:11], v[44:47], v[124:127], v[8:11]
    s_nop 7
    v_bfi_b32 v8, s50, v7, v8
    v_bfi_b32 v9, s50, v7, v9
    v_bfi_b32 v10, s50, v7, v10
    v_bfi_b32 v11, s50, v7, v11
    buffer_store_dwordx4 v[8:11], v5, s[28:31], s43 offen
    s_mov_b32 s52, 1
L_pollq:
    s_cmp_ge_u32 s41, 16
    s_cbranch_scc1 L_qglobal
    s_add_u32 s41, s41, 1
    buffer_load_dwordx4 v[48:51], v6, s[28:31], s44 offen offset:0 sc1
    buffer_load_dwordx4 v[52:55], v6, s[28:31], s44 offen offset:1024 sc1
    buffer_load_dwordx4 v[56:59], v6, s[28:31], s44 offen offset:2048 sc1
    buffer_load_dwordx4 v[60:63], v6, s[28:31], s44 offen offset:3072 sc1
    s_waitcnt vmcnt(0)
    v_xor_b32 v48, s53, v48
    v_xor_b32 v49, s53, v49
    v_xor_b32 v50, s53, v50
    v_xor_b32 v51, s53, v51
    v_xor_b32 v52, s53, v52
    v_xor_b32 v53, s53, v53
    v_xor_b32 v54, s53, v54
    v_xor_b32 v55, s53, v55
    v_xor_b32 v56, s53, v56
    v_xor_b32 v57, s53, v57
    v_xor_b32 v58, s53, v58
    v_xor_b32 v59, s53, v59
    v_xor_b32 v60, s53, v60
    v_xor_b32 v61, s53, v61
    v_xor_b32 v62, s53, v62
    v_xor_b32 v63, s53, v63
    v_or3_b32 v20, v48, v49, v50
    v_or3_b32 v20, v20, v51, v52
    v_or3_b32 v20, v20, v53, v54
    v_or3_b32 v20, v20, v55, v56
    v_or3_b32 v20, v20, v57, v58
    v_or3_b32 v20, v20, v59, v60
    v_or3_b32 v20, v20, v61, v62
    v_bitop3_b32 v20, v20, s50, v63 bitop3:0xc8
    v_cmp_ne_u32 vcc, 0, v20
    s_nop 0
    s_cbranch_vccnz L_pollq
L_qdone:
    s_waitcnt vmcnt(0)
    v_pk_add_f32 v[48:49], v[48:49], v[52:53]
    v_pk_add_f32 v[50:51], v[50:51], v[54:55]
    v_pk_add_f32 v[56:57], v[56:57], v[60:61]
    v_pk_add_f32 v[58:59], v[58:59], v[62:63]
    v_pk_add_f32 v[48:49], v[48:49], v[56:57]
    v_pk_add_f32 v[50:51], v[50:51], v[58:59]
    s_nop 1
    v_permlane32_swap_b32 v48, v50
    v_permlane32_swap_b32 v49, v51
    v_add_f32 v48, v48, v50
    v_add_f32 v49, v49, v51
    v_lshlrev_b32 v20, 4, v13
    v_bfe_u32 v21, v1, 4, 1
    v_lshl_add_u32 v20, v21, 3, v20
    v_lshrrev_b32 v21, 5, v1
    v_lshl_add_u32 v20, v21, 2, v20
    v_cvt_pk_bf16_f32 v48, v48, v49
    ds_write_b32 v20, v48 offset:0
    s_cmp_eq_u32 s52, 0
    s_cbranch_scc1 L_clr_g
    buffer_store_dword v16, v4, s[28:31], s45 offen
    s_branch L_clr_d
L_clr_g:
    buffer_store_dword v16, v4, s[28:31], s45 offen sc1
L_clr_d:
    s_waitcnt lgkmcnt(0)
    s_barrier
    v_and_b32 v20, 3, v1
    v_lshlrev_b32 v20, 3, v20
L_pollml:
    ds_read_b64 v[22:23], v20 offset:256
    s_add_u32 s41, s41, 1
    s_cmp_ge_u32 s41, 0x100000
    s_cbranch_scc1 L_mldone
    s_waitcnt lgkmcnt(0)
    v_max_u32 v24, v22, v23
    v_cmp_eq_u32 vcc, -1, v24
    s_nop 0
    s_cbranch_vccnz L_pollml
L_mldone:
    s_waitcnt vmcnt(0) lgkmcnt(0)
    v_max_f32_dpp v24, v22, v22 quad_perm:[1,0,3,2] row_mask:0xf bank_mask:0xf
    s_nop 1
    v_max_f32_dpp v24, v24, v24 quad_perm:[2,3,0,1] row_mask:0xf bank_mask:0xf
    v_sub_f32 v26, v22, v24
    v_exp_f32 v26, v26
    s_nop 0
    v_mul_f32 v25, v26, v23
    s_nop 1
    v_add_f32_dpp v25, v25, v25 quad_perm:[1,0,3,2] row_mask:0xf bank_mask:0xf
    s_nop 1
    v_add_f32_dpp v25, v25, v25 quad_perm:[2,3,0,1] row_mask:0xf bank_mask:0xf
    s_mov_b32 s37, 0xffff0000
    v_mov_b32 v21, s51
    v_and_or_b32 v36, v24, s37, v21
    v_lshl_or_b32 v37, v24, 16, v21
    v_and_or_b32 v38, v25, s37, v21
    v_lshl_or_b32 v39, v25, 16, v21
    s_lshl_b32 s37, s46, 2
    v_xor_b32 v20, s37, v1
    v_lshlrev_b32 v20, 7, v20
    s_mov_b64 exec, 0xff
    s_cmp_eq_u32 s52, 0
    s_cbranch_scc1 L_ml_g
    buffer_store_dwordx4 v[36:39], v6, s[28:31], s54 offen
    s_branch L_ml_d
L_ml_g:
    buffer_store_dwordx4 v[36:39], v6, s[28:31], s54 offen sc1
L_ml_d:
    s_andn2_b32 s54, s54, 0x3ff
L_pollml2:
    buffer_load_dwordx4 v[40:43], v20, s[28:31], s54 offen sc1
    s_add_u32 s41, s41, 1
    s_cmp_ge_u32 s41, 0x100000
    s_cbranch_scc1 L_ml2done
    s_waitcnt vmcnt(0)
    v_xor_b32 v40, s51, v40
    v_xor_b32 v41, s51, v41
    v_xor_b32 v42, s51, v42
    v_xor_b32 v43, s51, v43
    v_or3_b32 v24, v40, v41, v42
    v_or_b32 v24, v24, v43
    v_lshlrev_b32 v24, 16, v24
    v_cmp_ne_u32 vcc, 0, v24
    s_nop 0
    s_cbranch_vccnz L_pollml2
L_ml2done:
    s_waitcnt vmcnt(0)
    v_lshrrev_b32 v41, 16, v41
    v_lshrrev_b32 v43, 16, v43
    v_or_b32 v28, v40, v41
    v_or_b32 v29, v42, v43
    s_nop 0
    v_max_f32_dpp v24, v28, v28 quad_perm:[1,0,3,2] row_mask:0xf bank_mask:0xf
    s_nop 1
    v_max_f32_dpp v24, v24, v24 quad_perm:[2,3,0,1] row_mask:0xf bank_mask:0xf
    v_sub_f32 v26, v28, v24
    v_sub_f32 v27, v22, v24
    v_exp_f32 v26, v26
    v_exp_f32 v27, v27
    v_mul_f32 v25, v26, v29
    s_nop 1
    v_add_f32_dpp v25, v25, v25 quad_perm:[1,0,3,2] row_mask:0xf bank_mask:0xf
    s_nop 1
    v_add_f32_dpp v25, v25, v25 quad_perm:[2,3,0,1] row_mask:0xf bank_mask:0xf
    v_rcp_f32 v25, v25
    s_nop 0
    v_mul_f32 v27, v27, v25
    s_nop 0
    v_readlane_b32 s35, v27, 0
    v_readlane_b32 s36, v27, 1
    v_readlane_b32 s40, v27, 2
    v_readlane_b32 s47, v27, 3
    s_mov_b64 exec, -1
    v_lshlrev_b32 v20, 3, v1
    s_barrier
    ds_read_b64 v[40:41], v20 offset:512
    ds_read_b64 v[42:43], v20 offset:1024
    ds_read_b64 v[44:45], v20 offset:1536
    ds_read_b64 v[46:47], v20 offset:2048
    s_cmp_eq_u32 s52, 0
    s_waitcnt lgkmcnt(3)
    v_mul_f32 v36, s35, v40
    v_mul_f32 v37, s35, v41
    s_waitcnt lgkmcnt(2)
    v_fmac_f32 v36, s36, v42
    v_fmac_f32 v37, s36, v43
    s_waitcnt lgkmcnt(1)
    v_fmac_f32 v36, s40, v44
    v_fmac_f32 v37, s40, v45
    s_waitcnt lgkmcnt(0)
    v_fmac_f32 v36, s47, v46
    v_fmac_f32 v37, s47, v47
    v_cvt_pk_bf16_f32 v36, v36, v37
    v_min_u32 v36, -2, v36
    s_cbranch_scc1 L_o_g
    buffer_store_dword v36, v4, s[28:31], s45 offen
    s_barrier
    s_barrier
    s_endpgm
L_o_g:
    buffer_store_dword v36, v4, s[28:31], s45 offen sc1
    s_barrier
    s_barrier
    s_endpgm
L_qglobal:
    s_mov_b32 s52, 0
    v_or_b32 v8, 0x80, v8
    v_or_b32 v9, 0x80, v9
    v_or_b32 v10, 0x80, v10
    v_or_b32 v11, 0x80, v11
    buffer_store_dwordx4 v[8:11], v5, s[28:31], s43 offen sc1
    s_movk_i32 s37, 0xf0
L_pollqg:
    buffer_load_dwordx4 v[48:51], v6, s[28:31], s44 offen offset:0 sc1
    buffer_load_dwordx4 v[52:55], v6, s[28:31], s44 offen offset:1024 sc1
    buffer_load_dwordx4 v[56:59], v6, s[28:31], s44 offen offset:2048 sc1
    buffer_load_dwordx4 v[60:63], v6, s[28:31], s44 offen offset:3072 sc1
    s_add_u32 s41, s41, 1
    s_cmp_ge_u32 s41, 0x100000
    s_cbranch_scc1 L_qdone
    s_waitcnt vmcnt(0)
    v_bfe_i32 v20, v48, 7, 1
    v_and_b32 v20, s37, v20
    v_xor_b32 v48, s53, v48
    v_bfi_b32 v48, v20, 0, v48
    v_bfe_i32 v20, v49, 7, 1
    v_and_b32 v20, s37, v20
    v_xor_b32 v49, s53, v49
    v_bfi_b32 v49, v20, 0, v49
    v_bfe_i32 v20, v50, 7, 1
    v_and_b32 v20, s37, v20
    v_xor_b32 v50, s53, v50
    v_bfi_b32 v50, v20, 0, v50
    v_bfe_i32 v20, v51, 7, 1
    v_and_b32 v20, s37, v20
    v_xor_b32 v51, s53, v51
    v_bfi_b32 v51, v20, 0, v51
    v_bfe_i32 v20, v52, 7, 1
    v_and_b32 v20, s37, v20
    v_xor_b32 v52, s53, v52
    v_bfi_b32 v52, v20, 0, v52
    v_bfe_i32 v20, v53, 7, 1
    v_and_b32 v20, s37, v20
    v_xor_b32 v53, s53, v53
    v_bfi_b32 v53, v20, 0, v53
    v_bfe_i32 v20, v54, 7, 1
    v_and_b32 v20, s37, v20
    v_xor_b32 v54, s53, v54
    v_bfi_b32 v54, v20, 0, v54
    v_bfe_i32 v20, v55, 7, 1
    v_and_b32 v20, s37, v20
    v_xor_b32 v55, s53, v55
    v_bfi_b32 v55, v20, 0, v55
    v_bfe_i32 v20, v56, 7, 1
    v_and_b32 v20, s37, v20
    v_xor_b32 v56, s53, v56
    v_bfi_b32 v56, v20, 0, v56
    v_bfe_i32 v20, v57, 7, 1
    v_and_b32 v20, s37, v20
    v_xor_b32 v57, s53, v57
    v_bfi_b32 v57, v20, 0, v57
    v_bfe_i32 v20, v58, 7, 1
    v_and_b32 v20, s37, v20
    v_xor_b32 v58, s53, v58
    v_bfi_b32 v58, v20, 0, v58
    v_bfe_i32 v20, v59, 7, 1
    v_and_b32 v20, s37, v20
    v_xor_b32 v59, s53, v59
    v_bfi_b32 v59, v20, 0, v59
    v_bfe_i32 v20, v60, 7, 1
    v_and_b32 v20, s37, v20
    v_xor_b32 v60, s53, v60
    v_bfi_b32 v60, v20, 0, v60
    v_bfe_i32 v20, v61, 7, 1
    v_and_b32 v20, s37, v20
    v_xor_b32 v61, s53, v61
    v_bfi_b32 v61, v20, 0, v61
    v_bfe_i32 v20, v62, 7, 1
    v_and_b32 v20, s37, v20
    v_xor_b32 v62, s53, v62
    v_bfi_b32 v62, v20, 0, v62
    v_bfe_i32 v20, v63, 7, 1
    v_and_b32 v20, s37, v20
    v_xor_b32 v63, s53, v63
    v_bfi_b32 v63, v20, 0, v63
    v_or3_b32 v20, v48, v49, v50
    v_or3_b32 v20, v20, v51, v52
    v_or3_b32 v20, v20, v53, v54
    v_or3_b32 v20, v20, v55, v56
    v_or3_b32 v20, v20, v57, v58
    v_or3_b32 v20, v20, v59, v60
    v_or3_b32 v20, v20, v61, v62
    v_bitop3_b32 v20, v20, s50, v63 bitop3:0xc8
    v_cmp_ne_u32 vcc, 0, v20
    s_nop 0
    s_cbranch_vccnz L_pollqg
    s_branch L_qdone
L_exit:
    s_endpgm
.section .rodata,"a"
.p2align 6
.amdhsa_kernel standalone__sliding_block_cached__decode_kernel
  .amdhsa_next_free_vgpr 256
  .amdhsa_next_free_sgpr 56
  .amdhsa_accum_offset 256
  .amdhsa_group_segment_fixed_size 0
  .amdhsa_kernarg_size 64
  .amdhsa_user_sgpr_count 2
  .amdhsa_user_sgpr_kernarg_segment_ptr 1
  .amdhsa_system_sgpr_workgroup_id_x 1
  .amdhsa_float_denorm_mode_32 3
.end_amdhsa_kernel
```
